```python
import torch

def _softmax(x, axis=-1):
    return torch.softmax(x, dim=axis)

def _gelu(x):
    return torch.nn.functional.gelu(x, approximate='tanh')

def _silu(x):
    return torch.nn.functional.silu(x)

def _sigmoid(x):
    return torch.sigmoid(x)

def _layernorm(x, axis=-1, eps=1e-05):
    m = x.mean(dim=axis, keepdim=True)
    v = x.var(dim=axis, keepdim=True, unbiased=False)
    return (x - m) / torch.sqrt(v + eps)

def _scatter_add(tgt, idx, src, axis=0):
    return tgt.clone().index_add_(axis, idx, src)

def _segment_sum(src, seg, n):
    out = torch.zeros((n,) + src.shape[1:], dtype=src.dtype)
    return out.index_add_(0, seg, src)

def _pad(x, pw):
    flat = tuple((v for pair in reversed(pw) for v in pair))
    return torch.nn.functional.pad(x, flat)
kernel_name = 'adaLN_cond__spectral_fnet__moe_arch_mod__prompt'

def setup_inputs():

    _w = lambda a: (lambda t: t.to(torch.bfloat16) if t.is_floating_point() else t)(torch.as_tensor(a))

    def _A_setup():
        B, S, D = (1, 2048, 512)
        ns = torch.arange(S)[:, None] * torch.arange(S)[None, :]
        nd = torch.arange(D)[:, None] * torch.arange(D)[None, :]
        Ws_re = torch.cos(-2.0 * torch.pi * ns / S).to(float)
        Ws_im = torch.sin(-2.0 * torch.pi * ns / S).to(float)
        Wd_re = torch.cos(-2.0 * torch.pi * nd / D).to(float)
        Wd_im = torch.sin(-2.0 * torch.pi * nd / D).to(float)
        return {'x': _w((lambda *s: torch.randn(*s, dtype=torch.bfloat16) * 0.05)(B, S, D)), 'dft_seq_re': _w(Ws_re), 'dft_seq_im': _w(Ws_im), 'dft_hid_re': _w(Wd_re), 'dft_hid_im': _w(Wd_im)}
    _A_in = _A_setup()

    def _B_setup():
        B, S, D, F, C = (1, 2048, 512, 1792, 2)
        return {'x': _w((lambda *s: torch.randn(*s, dtype=torch.bfloat16) * 0.05)(B, S, D)), 'w_r': _w((lambda *s: torch.randn(*s, dtype=torch.bfloat16) * 3.2)(D)), 'w_gate': _w((lambda *s: torch.randn(*s, dtype=torch.bfloat16) * 0.8)(D, F)), 'w_up': _w((lambda *s: torch.randn(*s, dtype=torch.bfloat16) * 0.8)(D, F)), 'w_down': _w((lambda *s: torch.randn(*s, dtype=torch.bfloat16) * 0.8)(F, D))}
    _B_in = _B_setup()
    return {'A_x': _A_in['x'], 'A_dft_seq_re': _A_in['dft_seq_re'], 'A_dft_seq_im': _A_in['dft_seq_im'], 'A_dft_hid_re': _A_in['dft_hid_re'], 'A_dft_hid_im': _A_in['dft_hid_im'], 'B_x': _B_in['x'], 'B_w_r': _B_in['w_r'], 'B_w_gate': _B_in['w_gate'], 'B_w_up': _B_in['w_up'], 'B_w_down': _B_in['w_down'], 'c': _w((lambda *s: torch.randn(*s, dtype=torch.bfloat16) * 0.1)(1, 512) * 8.0), 'w_mod': _w((lambda *s: torch.randn(*s, dtype=torch.bfloat16) * 0.1)(512, 6 * 512) * 512 ** (-0.5) * 8.0)}

def reference(A_x, A_dft_seq_re, A_dft_seq_im, A_dft_hid_re, A_dft_hid_im, B_x, B_w_r, B_w_gate, B_w_up, B_w_down, c, w_mod):

    def _A_ref(x, dft_seq_re, dft_seq_im, dft_hid_re, dft_hid_im):
        a = torch.einsum('bsd,ed->bse', x, dft_hid_re)
        b = torch.einsum('bsd,ed->bse', x, dft_hid_im)
        y = torch.einsum('ts,bse->bte', dft_seq_re, a) - torch.einsum('ts,bse->bte', dft_seq_im, b)
        return y

    def _B_ref(x, w_r, w_gate, w_up, w_down):
        B, S, D = x.shape
        C = 2
        r = x @ w_r
        idx = torch.argsort(-r, axis=-1)[:, :C]
        idx_e = (lambda x, n, axis: torch.repeat_interleave(x, n, dim=axis))(idx.reshape(B, C, 1), D, axis=2)
        x_sel = (lambda x, i, axis: torch.take_along_dim(x, i, dim=axis))(x, idx_e, axis=1)
        g = _silu(x_sel @ w_gate)
        u = x_sel @ w_up
        y = g * u @ w_down
        r_sel = _sigmoid((lambda x, i, axis: torch.take_along_dim(x, i, dim=axis))(r, idx, axis=1))
        y = y * r_sel.reshape(B, C, 1)
        b_off = (torch.arange(B) * S).reshape(B, 1)
        flat_idx = (idx + b_off).reshape(B * C)
        zero = (x * 0.0).reshape(B * S, D)
        upd = _scatter_add(zero, flat_idx, y.reshape(B * C, D), axis=0)
        return x + upd.reshape(B, S, D)
    x = A_x
    mod = (_silu(c) @ w_mod).reshape(c.shape[0], 6, 1, -1)
    sa, ca, ga, sb, cb, gb = (mod[:, 0].clone(), mod[:, 1].clone(), mod[:, 2].clone(), mod[:, 3].clone(), mod[:, 4].clone(), mod[:, 5].clone())
    h = _layernorm(x, axis=-1) * (1 + ca) + sa
    x = x + ga * _A_ref(h, A_dft_seq_re, A_dft_seq_im, A_dft_hid_re, A_dft_hid_im)
    h = _layernorm(x, axis=-1) * (1 + cb) + sb
    x = x + gb * _B_ref(h, B_w_r, B_w_gate, B_w_up, B_w_down)
    return x
```

```asm
; @launch grid=(256,1,1) block=(512,1,1) lds=64640
.amdgcn_target "amdgcn-amd-amdhsa--gfx950"
.text
.globl adaLN_cond__spectral_fnet__moe_arch_mod__prompt_kernel
.p2align 8
.type adaLN_cond__spectral_fnet__moe_arch_mod__prompt_kernel,@function
adaLN_cond__spectral_fnet__moe_arch_mod__prompt_kernel:
    s_cmp_ge_u32 s2, 256
    s_cbranch_scc1 L_END
    s_load_dwordx2 s[32:33], s[0:1], 0
    s_load_dwordx2 s[6:7], s[0:1], 112
    s_load_dwordx16 s[8:23], s[0:1], 48
    s_sub_u32 s2, s2, 15
    s_cselect_b32 s3, 256, 0
    s_add_u32 s2, s2, s3
    s_cmp_lt_u32 s2, 129
    s_cbranch_scc1 L_MAIN
    s_cmp_ge_u32 s2, 225
    s_cbranch_scc0 L_MODH
    s_getpc_b64 s[40:41]
L_PC:
    v_lshlrev_b32_e64 v1, 7, v0
    v_min_u32 v1, L_CODE_END-L_PC-4, v1
    v_mov_b32 v3, s41
    v_add_co_u32 v2, vcc, s40, v1
    s_nop 1
    v_addc_co_u32 v3, vcc, 0, v3, vcc
    v_cmp_gt_u32 vcc, 128, v0
    s_nop 0
    s_and_saveexec_b64 s[42:43], vcc
    s_nop 2
    s_cbranch_execz L_PF_SKIP
    global_load_dword v200, v[2:3], off
L_PF_SKIP:
    s_mov_b64 exec, -1
    s_branch L_FILL
L_MODH:
    s_sub_u32 s40, s2, 129
    s_and_b32 s41, s40, 7
    s_lshr_b32 s42, s40, 4
    s_lshl_b32 s42, s42, 3
    s_add_u32 s41, s41, s42
    s_lshl_b32 s41, s41, 1
    s_bfe_u32 s42, s40, 0x10003
    s_add_u32 s41, s41, s42
    s_lshl_b32 s42, s42, 6
    s_lshl_b32 s44, s41, 6
    s_add_u32 s45, s44, 786432
    s_add_u32 s46, s44, 1572864
    s_add_u32 s47, s44, 2359296
    v_lshrrev_b32 v1, 2, v0
    v_xor_b32 v1, s42, v1
    v_and_b32_e64 v2, 3, v0
    v_mul_u32_u24 v3, 6144, v1
    v_lshl_add_u32 v3, v2, 4, v3
    v_lshlrev_b32 v4, 1, v1
    s_waitcnt lgkmcnt(0)
    s_mov_b32 s24, s16
    s_mov_b32 s25, s17
    s_mov_b32 s26, 0x400
    s_mov_b32 s27, 0x20000
    s_mov_b32 s28, s18
    s_mov_b32 s29, s19
    s_mov_b32 s30, 0x300000
    s_mov_b32 s31, 0x20000
    buffer_load_ushort v28, v4, s[24:27], 0 offen offset:0
    buffer_load_ushort v29, v4, s[24:27], 0 offen offset:256
    buffer_load_ushort v30, v4, s[24:27], 0 offen offset:512
    buffer_load_ushort v31, v4, s[24:27], 0 offen offset:768
    s_barrier
    buffer_load_dwordx4 v[12:15], v3, s[28:31], s44 offen
    buffer_load_dwordx4 v[16:19], v3, s[28:31], s45 offen
    buffer_load_dwordx4 v[20:23], v3, s[28:31], s46 offen
    buffer_load_dwordx4 v[24:27], v3, s[28:31], s47 offen
    s_branch M_REST
L_MAIN:
    v_and_b32_e64 v1, 15, v0
    v_bfe_u32 v2, v0, 4, 2
    v_lshrrev_b32_e64 v3, 6, v0
    s_lshr_b32 s41, s2, 5
    s_and_b32 s40, s2, 31
    v_lshl_add_u32 v4, s41, 1, v3
    v_and_b32_e64 v4, 7, v4
    v_lshl_add_u32 v4, v4, 3, v2
    v_lshlrev_b32_e64 v132, 15, v4
    v_lshl_add_u32 v132, v1, 4, v132
    v_add_u32 v133, 0x20000, v132
    s_lshl_b32 s44, s40, 2
    s_add_u32 s44, s44, s41
    s_lshl_b32 s44, s44, 8
    s_cmp_eq_u32 s2, 128
    s_cselect_b32 s34, 0, 0x200000
    s_mov_b32 s35, 0x20000
    s_xor_b32 s45, s44, 256
    s_xor_b32 s46, s44, 512
    s_xor_b32 s47, s44, 768
    s_waitcnt lgkmcnt(0)
    buffer_load_dwordx4 v[140:143], v132, s[32:35], s44 offen
    buffer_load_dwordx4 v[156:159], v133, s[32:35], s44 offen
    buffer_load_dwordx4 v[144:147], v132, s[32:35], s45 offen
    buffer_load_dwordx4 v[160:163], v133, s[32:35], s45 offen
    buffer_load_dwordx4 v[148:151], v132, s[32:35], s46 offen
    buffer_load_dwordx4 v[164:167], v133, s[32:35], s46 offen
    buffer_load_dwordx4 v[152:155], v132, s[32:35], s47 offen
    buffer_load_dwordx4 v[168:171], v133, s[32:35], s47 offen
    s_mov_b32 s34, 0x200000
    v_readfirstlane_b32 s53, v3
    s_mov_b32 s3, 0x301000
    s_load_dwordx8 s[72:79], s[6:7], s3
    s_load_dwordx2 s[68:69], s[6:7], s3 offset:32
    s_mov_b32 s24, s6
    s_mov_b32 s25, s7
    s_mov_b32 s26, 0x600000
    s_mov_b32 s27, 0x20000
    v_mul_u32_u24 v137, 288, v4
    v_lshl_add_u32 v137, v1, 4, v137
    v_and_b32 v135, 3, v3
    v_lshrrev_b32 v136, 2, v3
    v_and_b32 v9, 63, v0
    v_lshlrev_b32_e64 v10, 4, v9
    v_lshl_add_u32 v177, v135, 11, v10
    s_cmp_ge_u32 s53, 4
    s_nop 1
    s_cbranch_scc1 A_NOC
    v_lshl_add_u32 v172, v135, 4, v1
    v_lshrrev_b32 v173, 1, v172
    v_and_b32 v174, 1, v172
    v_cmp_eq_u32 vcc, 1, v172
    v_cvt_f32_u32 v176, v2
    v_mul_f32 v176, 4.0, v176
    v_cndmask_b32_e64 v173, v173, 32, vcc
    v_cndmask_b32_e64 v174, v174, 0, vcc
    v_cvt_f32_u32 v173, v173
    v_cvt_f32_u32 v174, v174
    v_mul_f32 v173, 0x3c800000, v173
    v_mul_f32 v174, 0x3e800000, v174
    v_fma_f32 v175, v173, v176, v174
    v_fmamk_f32 v92, v173, 0x00000000, v175
    v_fmamk_f32 v93, v173, 0x3f800000, v175
    v_fmamk_f32 v94, v173, 0x40000000, v175
    v_fmamk_f32 v95, v173, 0x40400000, v175
    v_fmamk_f32 v96, v173, 0x41800000, v175
    v_fmamk_f32 v97, v173, 0x41880000, v175
    v_fmamk_f32 v98, v173, 0x41900000, v175
    v_fmamk_f32 v99, v173, 0x41980000, v175
    v_cos_f32 v92, v92
    v_cos_f32 v93, v93
    v_cos_f32 v94, v94
    v_cos_f32 v95, v95
    v_cos_f32 v96, v96
    v_cos_f32 v97, v97
    v_cos_f32 v98, v98
    v_cos_f32 v99, v99
    v_cvt_pk_f16_f32 v100, v92, v93
    v_cvt_pk_f16_f32 v101, v94, v95
    v_cvt_pk_f16_f32 v102, v96, v97
    v_cvt_pk_f16_f32 v103, v98, v99
    ds_write_b128 v177, v[100:103] offset:34944
    v_fmamk_f32 v92, v173, 0x42000000, v175
    v_fmamk_f32 v93, v173, 0x42040000, v175
    v_fmamk_f32 v94, v173, 0x42080000, v175
    v_fmamk_f32 v95, v173, 0x420c0000, v175
    v_fmamk_f32 v96, v173, 0x42400000, v175
    v_fmamk_f32 v97, v173, 0x42440000, v175
    v_fmamk_f32 v98, v173, 0x42480000, v175
    v_fmamk_f32 v99, v173, 0x424c0000, v175
    v_cos_f32 v92, v92
    v_cos_f32 v93, v93
    v_cos_f32 v94, v94
    v_cos_f32 v95, v95
    v_cos_f32 v96, v96
    v_cos_f32 v97, v97
    v_cos_f32 v98, v98
    v_cos_f32 v99, v99
    v_cvt_pk_f16_f32 v104, v92, v93
    v_cvt_pk_f16_f32 v105, v94, v95
    v_cvt_pk_f16_f32 v106, v96, v97
    v_cvt_pk_f16_f32 v107, v98, v99
    ds_write_b128 v177, v[104:107] offset:35968
    s_nop 1
A_NOC:
    s_cmp_eq_u32 s40, 0
    s_cselect_b32 s55, 5, 6
    s_lshl_b32 s64, s41, 3
    s_lshl_b32 s64, s64, s55
    s_add_u32 s64, s64, s40
    v_lshrrev_b32_e64 v4, 2, v1
    v_lshl_add_u32 v4, v2, 2, v4
    v_mul_u32_u24 v138, 288, v4
    v_lshl_add_u32 v138, v136, 7, v138
    v_and_b32_e64 v4, 3, v1
    v_lshl_add_u32 v138, v4, 3, v138
    v_lshl_add_u32 v134, v135, 2, v2
    v_mul_u32_u24 v134, 1024, v134
    v_lshl_add_u32 v134, v136, 8, v134
    v_lshl_add_u32 v134, v1, 4, v134
    s_mul_i32 s48, s40, 65536
    s_lshl_b32 s49, s41, 14
    s_add_u32 s48, s48, s49
    s_add_u32 s48, s48, 0x400000
    s_cmp_eq_u32 s2, 128
    s_cselect_b32 s48, 0x7fff0000, s48
    s_cselect_b32 s61, s53, 0
    s_add_u32 s49, s48, 512
    s_lshl_b32 s52, s53, s55
    s_add_u32 s52, s52, s64
    s_sub_u32 s56, 2048, s52
    s_lshl_b32 s57, s52, 10
    s_lshl_b32 s58, s56, 10
    s_cmp_eq_u32 s61, 0
    s_cselect_b32 s59, 0xfffffe00, 0
    s_cselect_b32 s57, s57, 0x7fff0000
    s_and_b32 s61, s52, 1023
    s_cmp_lg_u32 s61, 0
    s_cselect_b32 s60, s59, 0
    s_cmp_lg_u32 s60, 0
    s_cselect_b32 s58, s58, 0x7fff0000
    v_lshlrev_b32 v20, 3, v9
    s_mov_b32 s28, s8
    s_mov_b32 s29, s9
    s_mov_b32 s30, 0x400
    s_mov_b32 s31, 0x20000
    s_mov_b32 s50, 0x3b003b00
    v_mov_b32 v192, 0x3b000000
    v_mov_b32 v193, 0x3727c5ac
    v_mov_b32 v194, 0xfffcfffc
    s_waitcnt lgkmcnt(0)
    s_add_u32 s68, s68, 0x9e3779b9
    s_addc_u32 s69, s69, 0x7f4a7c15
    s_or_b32 s72, s72, 0xfffcfffc
    s_or_b32 s73, s73, 0xfffcfffc
    s_or_b32 s74, s74, 0xfffcfffc
    s_or_b32 s75, s75, 0xfffcfffc
    s_add_u32 s72, s72, 1
    s_addc_u32 s73, s73, 0
    s_addc_u32 s74, s74, 0
    s_addc_u32 s75, s75, 0
    s_and_b32 s72, s72, 0x30003
    s_and_b32 s73, s73, 0x30003
    s_and_b32 s74, s74, 0x30003
    s_and_b32 s75, s75, 0x30003
    s_add_u32 s76, s76, 1
    s_and_b32 s76, s76, 0xffff
    s_add_u32 s77, s77, 1
    s_and_b32 s77, s77, 0xffff
    s_add_u32 s78, s78, 1
    s_and_b32 s78, s78, 0xffff
    s_add_u32 s79, s79, 1
    s_and_b32 s79, s79, 0xffff
    v_mov_b32 v124, s72
    v_mov_b32 v128, s76
    v_mov_b32 v125, s73
    v_mov_b32 v129, s77
    v_mov_b32 v126, s74
    v_mov_b32 v130, s78
    v_mov_b32 v127, s75
    v_mov_b32 v131, s79
    s_waitcnt vmcnt(7)
    v_dot2_f32_bf16 v188, v140, s50, 0
    v_dot2_f32_bf16 v190, v140, v140, 0
    s_waitcnt vmcnt(6)
    v_dot2_f32_bf16 v189, v156, s50, 0
    v_dot2_f32_bf16 v191, v156, v156, 0
    v_dot2_f32_bf16 v188, v141, s50, v188
    v_dot2_f32_bf16 v190, v141, v141, v190
    v_dot2_f32_bf16 v189, v157, s50, v189
    v_dot2_f32_bf16 v191, v157, v157, v191
    v_dot2_f32_bf16 v188, v142, s50, v188
    v_dot2_f32_bf16 v190, v142, v142, v190
    v_dot2_f32_bf16 v189, v158, s50, v189
    v_dot2_f32_bf16 v191, v158, v158, v191
    v_dot2_f32_bf16 v188, v143, s50, v188
    v_dot2_f32_bf16 v190, v143, v143, v190
    v_dot2_f32_bf16 v189, v159, s50, v189
    v_dot2_f32_bf16 v191, v159, v159, v191
    v_lshlrev_b32 v92, 16, v140
    v_and_b32 v93, 0xffff0000, v140
    v_lshlrev_b32_e64 v94, 16, v141
    v_and_b32 v95, 0xffff0000, v141
    v_lshlrev_b32_e64 v96, 16, v142
    v_and_b32 v97, 0xffff0000, v142
    v_lshlrev_b32_e64 v98, 16, v143
    v_and_b32 v99, 0xffff0000, v143
    v_lshlrev_b32_e64 v100, 16, v156
    v_and_b32 v101, 0xffff0000, v156
    v_lshlrev_b32_e64 v102, 16, v157
    v_and_b32 v103, 0xffff0000, v157
    v_lshlrev_b32_e64 v104, 16, v158
    v_and_b32 v105, 0xffff0000, v158
    v_lshlrev_b32_e64 v106, 16, v159
    v_and_b32 v107, 0xffff0000, v159
    s_waitcnt vmcnt(5)
    v_dot2_f32_bf16 v188, v144, s50, v188
    v_dot2_f32_bf16 v190, v144, v144, v190
    s_waitcnt vmcnt(4)
    v_dot2_f32_bf16 v189, v160, s50, v189
    v_dot2_f32_bf16 v191, v160, v160, v191
    v_dot2_f32_bf16 v188, v145, s50, v188
    v_dot2_f32_bf16 v190, v145, v145, v190
    v_dot2_f32_bf16 v189, v161, s50, v189
    v_dot2_f32_bf16 v191, v161, v161, v191
    v_dot2_f32_bf16 v188, v146, s50, v188
    v_dot2_f32_bf16 v190, v146, v146, v190
    v_dot2_f32_bf16 v189, v162, s50, v189
    v_dot2_f32_bf16 v191, v162, v162, v191
    v_dot2_f32_bf16 v188, v147, s50, v188
    v_dot2_f32_bf16 v190, v147, v147, v190
    v_dot2_f32_bf16 v189, v163, s50, v189
    v_dot2_f32_bf16 v191, v163, v163, v191
    s_waitcnt vmcnt(3)
    v_dot2_f32_bf16 v188, v148, s50, v188
    v_dot2_f32_bf16 v190, v148, v148, v190
    s_waitcnt vmcnt(2)
    v_dot2_f32_bf16 v189, v164, s50, v189
    v_dot2_f32_bf16 v191, v164, v164, v191
    v_dot2_f32_bf16 v188, v149, s50, v188
    v_dot2_f32_bf16 v190, v149, v149, v190
    v_dot2_f32_bf16 v189, v165, s50, v189
    v_dot2_f32_bf16 v191, v165, v165, v191
    v_dot2_f32_bf16 v188, v150, s50, v188
    v_dot2_f32_bf16 v190, v150, v150, v190
    v_dot2_f32_bf16 v189, v166, s50, v189
    v_dot2_f32_bf16 v191, v166, v166, v191
    v_dot2_f32_bf16 v188, v151, s50, v188
    v_dot2_f32_bf16 v190, v151, v151, v190
    v_dot2_f32_bf16 v189, v167, s50, v189
    v_dot2_f32_bf16 v191, v167, v167, v191
    s_waitcnt vmcnt(1)
    v_dot2_f32_bf16 v188, v152, s50, v188
    v_dot2_f32_bf16 v190, v152, v152, v190
    s_waitcnt vmcnt(0)
    v_dot2_f32_bf16 v189, v168, s50, v189
    v_dot2_f32_bf16 v191, v168, v168, v191
    v_dot2_f32_bf16 v188, v153, s50, v188
    v_dot2_f32_bf16 v190, v153, v153, v190
    v_dot2_f32_bf16 v189, v169, s50, v189
    v_dot2_f32_bf16 v191, v169, v169, v191
    v_dot2_f32_bf16 v188, v154, s50, v188
    v_dot2_f32_bf16 v190, v154, v154, v190
    v_dot2_f32_bf16 v189, v170, s50, v189
    v_dot2_f32_bf16 v191, v170, v170, v191
    v_dot2_f32_bf16 v188, v155, s50, v188
    v_dot2_f32_bf16 v190, v155, v155, v190
    v_dot2_f32_bf16 v189, v171, s50, v189
    v_dot2_f32_bf16 v191, v171, v171, v191
    buffer_load_dwordx4 v[108:111], v10, s[32:35], s57 offen
    buffer_load_dwordx4 v[112:115], v10, s[32:35], s58 offen
    buffer_load_dwordx2 v[116:117], v20, s[28:31], 0 offen
    buffer_load_dwordx2 v[118:119], v20, s[28:31], 0 offen offset:512
    v_add_f32_dpp v188, v188, v188 row_ror:8 row_mask:0xf bank_mask:0xf
    v_add_f32_dpp v189, v189, v189 row_ror:8 row_mask:0xf bank_mask:0xf
    v_add_f32_dpp v190, v190, v190 row_ror:8 row_mask:0xf bank_mask:0xf
    v_add_f32_dpp v191, v191, v191 row_ror:8 row_mask:0xf bank_mask:0xf
    v_add_f32_dpp v188, v188, v188 row_ror:4 row_mask:0xf bank_mask:0xf
    v_add_f32_dpp v189, v189, v189 row_ror:4 row_mask:0xf bank_mask:0xf
    v_add_f32_dpp v190, v190, v190 row_ror:4 row_mask:0xf bank_mask:0xf
    v_add_f32_dpp v191, v191, v191 row_ror:4 row_mask:0xf bank_mask:0xf
    v_add_f32_dpp v188, v188, v188 row_ror:2 row_mask:0xf bank_mask:0xf
    v_add_f32_dpp v189, v189, v189 row_ror:2 row_mask:0xf bank_mask:0xf
    v_add_f32_dpp v190, v190, v190 row_ror:2 row_mask:0xf bank_mask:0xf
    v_add_f32_dpp v191, v191, v191 row_ror:2 row_mask:0xf bank_mask:0xf
    v_add_f32_dpp v188, v188, v188 row_ror:1 row_mask:0xf bank_mask:0xf
    v_add_f32_dpp v189, v189, v189 row_ror:1 row_mask:0xf bank_mask:0xf
    v_add_f32_dpp v190, v190, v190 row_ror:1 row_mask:0xf bank_mask:0xf
    v_add_f32_dpp v191, v191, v191 row_ror:1 row_mask:0xf bank_mask:0xf
    v_pk_mul_f32 v[196:197], v[188:189], v[188:189]
    v_pk_fma_f32 v[190:191], v[190:191], v[192:193], v[196:197] op_sel:[0,0,0] op_sel_hi:[1,0,1] neg_lo:[0,0,1] neg_hi:[0,0,1]
    v_max_f32 v190, 0, v190
    v_max_f32 v191, 0, v191
    v_pk_add_f32 v[190:191], v[190:191], v[192:193] op_sel:[0,1] op_sel_hi:[1,1]
    v_rsq_f32 v190, v190
    v_rsq_f32_e64 v191, v191
    s_nop 0
    v_pk_mul_f32 v[188:189], v[188:189], v[190:191]
    v_pk_fma_f32 v[92:93], v[92:93], v[190:191], v[188:189] op_sel:[0,0,0] op_sel_hi:[1,0,0] neg_lo:[0,0,1] neg_hi:[0,0,1]
    v_pk_fma_f32 v[94:95], v[94:95], v[190:191], v[188:189] op_sel:[0,0,0] op_sel_hi:[1,0,0] neg_lo:[0,0,1] neg_hi:[0,0,1]
    v_pk_fma_f32 v[96:97], v[96:97], v[190:191], v[188:189] op_sel:[0,0,0] op_sel_hi:[1,0,0] neg_lo:[0,0,1] neg_hi:[0,0,1]
    v_pk_fma_f32 v[98:99], v[98:99], v[190:191], v[188:189] op_sel:[0,0,0] op_sel_hi:[1,0,0] neg_lo:[0,0,1] neg_hi:[0,0,1]
    v_cvt_pk_f16_f32 v196, v92, v93
    v_cvt_pk_f16_f32 v197, v94, v95
    v_cvt_pk_f16_f32 v198, v96, v97
    v_cvt_pk_f16_f32 v199, v98, v99
    ds_write_b128 v137, v[196:199] offset:0
    v_pk_fma_f32 v[100:101], v[100:101], v[190:191], v[188:189] op_sel:[0,1,1] op_sel_hi:[1,1,1] neg_lo:[0,0,1] neg_hi:[0,0,1]
    v_pk_fma_f32 v[102:103], v[102:103], v[190:191], v[188:189] op_sel:[0,1,1] op_sel_hi:[1,1,1] neg_lo:[0,0,1] neg_hi:[0,0,1]
    v_pk_fma_f32 v[104:105], v[104:105], v[190:191], v[188:189] op_sel:[0,1,1] op_sel_hi:[1,1,1] neg_lo:[0,0,1] neg_hi:[0,0,1]
    v_pk_fma_f32 v[106:107], v[106:107], v[190:191], v[188:189] op_sel:[0,1,1] op_sel_hi:[1,1,1] neg_lo:[0,0,1] neg_hi:[0,0,1]
    v_cvt_pk_f16_f32 v200, v100, v101
    v_cvt_pk_f16_f32 v201, v102, v103
    v_cvt_pk_f16_f32 v202, v104, v105
    v_cvt_pk_f16_f32 v203, v106, v107
    ds_write_b128 v137, v[200:203] offset:1152
    s_waitcnt lgkmcnt(0)
    s_barrier
    s_setprio 2
    ds_read_b128 v[180:183], v177 offset:34944
    ds_read_b128 v[184:187], v177 offset:35968
    ds_read_b64_tr_b16 v[140:141], v138 offset:0
    ds_read_b64_tr_b16 v[142:143], v138 offset:4608
    ds_read_b64_tr_b16 v[144:145], v138 offset:9216
    ds_read_b64_tr_b16 v[146:147], v138 offset:13824
    ds_read_b64_tr_b16 v[148:149], v138 offset:32
    ds_read_b64_tr_b16 v[150:151], v138 offset:4640
    ds_read_b64_tr_b16 v[152:153], v138 offset:9248
    ds_read_b64_tr_b16 v[154:155], v138 offset:13856
    ds_read_b64_tr_b16 v[156:157], v138 offset:64
    ds_read_b64_tr_b16 v[158:159], v138 offset:4672
    ds_read_b64_tr_b16 v[160:161], v138 offset:9280
    ds_read_b64_tr_b16 v[162:163], v138 offset:13888
    ds_read_b64_tr_b16 v[164:165], v138 offset:96
    ds_read_b64_tr_b16 v[166:167], v138 offset:4704
    ds_read_b64_tr_b16 v[168:169], v138 offset:9312
    ds_read_b64_tr_b16 v[170:171], v138 offset:13920
    s_waitcnt lgkmcnt(14)
    v_mfma_f32_16x16x32_f16 v[204:207], v[180:183], v[140:143], 0
    s_waitcnt lgkmcnt(12)
    v_mfma_f32_16x16x32_f16 v[204:207], v[184:187], v[144:147], v[204:207]
    s_waitcnt lgkmcnt(10)
    v_mfma_f32_16x16x32_f16 v[208:211], v[180:183], v[148:151], 0
    s_waitcnt lgkmcnt(8)
    v_mfma_f32_16x16x32_f16 v[208:211], v[184:187], v[152:155], v[208:211]
    s_waitcnt lgkmcnt(6)
    v_mfma_f32_16x16x32_f16 v[212:215], v[180:183], v[156:159], 0
    s_waitcnt lgkmcnt(4)
    v_mfma_f32_16x16x32_f16 v[212:215], v[184:187], v[160:163], v[212:215]
    s_waitcnt lgkmcnt(2)
    v_mfma_f32_16x16x32_f16 v[216:219], v[180:183], v[164:167], 0
    s_waitcnt lgkmcnt(0)
    v_mfma_f32_16x16x32_f16 v[216:219], v[184:187], v[168:171], v[216:219]
    v_cvt_pk_f16_f32 v92, v204, v205
    v_cvt_pk_f16_f32 v96, v206, v207
    v_add_u32 v92, 0x00020002, v92
    v_add_u32 v96, 0x00020002, v96
    v_bitop3_b32 v92, v92, v194, v124 bitop3:0xea
    v_bitop3_b32 v96, v96, v194, v124 bitop3:0xea
    v_cvt_pk_f16_f32 v93, v208, v209
    v_cvt_pk_f16_f32 v97, v210, v211
    v_add_u32 v93, 0x00020002, v93
    v_add_u32 v97, 0x00020002, v97
    v_bitop3_b32 v93, v93, v194, v125 bitop3:0xea
    v_bitop3_b32 v97, v97, v194, v125 bitop3:0xea
    v_cvt_pk_f16_f32 v94, v212, v213
    v_cvt_pk_f16_f32 v98, v214, v215
    v_add_u32 v94, 0x00020002, v94
    v_add_u32 v98, 0x00020002, v98
    v_bitop3_b32 v94, v94, v194, v126 bitop3:0xea
    v_bitop3_b32 v98, v98, v194, v126 bitop3:0xea
    v_cvt_pk_f16_f32 v95, v216, v217
    v_cvt_pk_f16_f32 v99, v218, v219
    v_add_u32 v95, 0x00020002, v95
    v_add_u32 v99, 0x00020002, v99
    v_bitop3_b32 v95, v95, v194, v127 bitop3:0xea
    v_bitop3_b32 v99, v99, v194, v127 bitop3:0xea
    buffer_store_dwordx4 v[92:95], v134, s[24:27], s48 offen sc1
    buffer_store_dwordx4 v[96:99], v134, s[24:27], s49 offen sc1
    s_setprio 0
    s_cmp_eq_u32 s40, 0
    s_cselect_b32 s65, 0, 0xbe800000
    s_cselect_b64 s[66:67], -1, 0
    v_cvt_f32_u32 v176, v2
    v_mul_f32 v176, 4.0, v176
    v_lshl_add_u32 v175, v3, 10, v10
    v_and_b32 v174, 1, v3
    v_cvt_f32_u32 v174, v174
    v_lshrrev_b32 v4, 2, v1
    v_and_b32 v5, 3, v1
    v_lshl_add_u32 v4, v4, 3, v5
    v_cvt_f32_u32_e64 v172, v4
    v_fmamk_f32 v172, v174, 0x40800000, v172
    s_cmp_lt_u32 s53, 4
    s_nop 1
    s_cbranch_scc1 C_JOB_B
    s_cmp_ge_u32 s53, 6
    s_cselect_b32 s61, 0xbe800000, 0
    v_mul_f32 v4, 0x3d000000, v172
    v_add_f32_e64 v5, v176, v176
    v_fma_f32 v5, v5, v4, s61
    v_fmamk_f32 v76, v4, 0x00000000, v5
    v_fmamk_f32 v77, v4, 0x3f800000, v5
    v_fmamk_f32 v78, v4, 0x40000000, v5
    v_fmamk_f32 v79, v4, 0x40400000, v5
    v_fmamk_f32 v80, v4, 0x40800000, v5
    v_fmamk_f32 v81, v4, 0x40a00000, v5
    v_fmamk_f32 v82, v4, 0x40c00000, v5
    v_fmamk_f32 v83, v4, 0x40e00000, v5
    v_cos_f32 v76, v76
    v_cos_f32 v77, v77
    v_cos_f32 v78, v78
    v_cos_f32 v79, v79
    v_cos_f32 v80, v80
    v_cos_f32 v81, v81
    v_cos_f32 v82, v82
    v_cos_f32 v83, v83
    v_cvt_pk_bf16_f32 v84, v76, v77
    v_cvt_pk_bf16_f32 v85, v78, v79
    v_cvt_pk_bf16_f32 v86, v80, v81
    v_cvt_pk_bf16_f32 v87, v82, v83
    ds_write_b128 v175, v[84:87] offset:39040
    s_nop 1
    s_branch C_JOB_END
C_JOB_B:
    s_cmp_ge_u32 s53, 2
    s_cbranch_scc1 C_JOB_C
    v_lshrrev_b32 v4, 1, v1
    v_lshlrev_b32 v4, s55, v4
    v_add_u32 v4, s64, v4
    v_cvt_f32_u32 v172, v4
    v_mul_f32 v172, 0x3a000000, v172
    v_and_b32 v5, 1, v1
    v_cvt_f32_u32 v4, v5
    v_mul_f32 v4, 0x3e800000, v4
    v_fmamk_f32 v5, v174, 0x41800000, v176
    v_fma_f32 v173, v172, v5, v4
    v_add_f32 v178, s65, v173
    v_and_b32 v4, 2, v1
    v_lshlrev_b32_e64 v4, 3, v4
    v_mov_b32 v5, 0xffff
    v_lshlrev_b32_e64 v17, v4, v5
    v_cndmask_b32_e64 v17, -1, v17, s[66:67]
    v_fmamk_f32 v76, v172, 0x00000000, v173
    v_fmamk_f32 v77, v172, 0x00000000, v178
    v_fmamk_f32 v78, v172, 0x3f800000, v173
    v_fmamk_f32 v79, v172, 0x3f800000, v178
    v_fmamk_f32 v80, v172, 0x40000000, v173
    v_fmamk_f32 v81, v172, 0x40000000, v178
    v_fmamk_f32 v82, v172, 0x40400000, v173
    v_fmamk_f32 v83, v172, 0x40400000, v178
    v_cos_f32 v76, v76
    v_cos_f32 v77, v77
    v_cos_f32 v78, v78
    v_cos_f32 v79, v79
    v_cos_f32 v80, v80
    v_cos_f32 v81, v81
    v_cos_f32 v82, v82
    v_cos_f32 v83, v83
    v_cvt_pk_f16_f32 v84, v76, v77
    v_cvt_pk_f16_f32 v85, v78, v79
    v_cvt_pk_f16_f32 v86, v80, v81
    v_cvt_pk_f16_f32 v87, v82, v83
    v_and_b32 v84, v17, v84
    v_and_b32 v85, v17, v85
    v_and_b32 v86, v17, v86
    v_and_b32 v87, v17, v87
    ds_write_b128 v175, v[84:87] offset:47232
    s_nop 1
    s_branch C_JOB_END
C_JOB_C:
    v_mul_f32 v4, 0x3b000000, v172
    v_mul_f32_e64 v5, v176, v4
    v_fmamk_f32 v76, v4, 0x00000000, v5
    v_fmamk_f32 v77, v4, 0x3f800000, v5
    v_fmamk_f32 v78, v4, 0x40000000, v5
    v_fmamk_f32 v79, v4, 0x40400000, v5
    v_cvt_f32_u32_e64 v4, v1
    v_mul_f32 v4, 0x3d800000, v4
    v_mul_f32 v5, 0xbe800000, v174
    v_fma_f32 v5, v176, v4, v5
    v_fmamk_f32 v80, v4, 0x00000000, v5
    v_fmamk_f32 v81, v4, 0x3f800000, v5
    v_fmamk_f32 v82, v4, 0x40000000, v5
    v_fmamk_f32 v83, v4, 0x40400000, v5
    v_cos_f32 v84, v76
    v_sin_f32 v88, v76
    v_cos_f32 v80, v80
    v_cos_f32 v85, v77
    v_sin_f32 v89, v77
    v_cos_f32 v81, v81
    v_cos_f32 v86, v78
    v_sin_f32 v90, v78
    v_cos_f32 v82, v82
    v_cos_f32 v87, v79
    v_sin_f32 v91, v79
    v_cos_f32 v83, v83
    v_and_b32_e64 v4, 1, v3
    v_lshl_add_u32 v5, v4, 11, v10
    v_lshl_add_u32 v4, v4, 3, v10
    v_cvt_pk_bf16_f32 v76, v80, v81
    v_cvt_pk_bf16_f32 v77, v82, v83
    ds_write_b128 v5, v[84:87] offset:49280
    ds_write_b128 v5, v[88:91] offset:50304
    ds_write_b64 v4, v[76:77] offset:53376
C_JOB_END:
    v_lshl_add_u32 v21, s41, 1, v3
    v_add_u32 v21, 2, v21
    v_and_b32 v21, 7, v21
    v_lshlrev_b32_e64 v7, 8, v21
    v_mul_u32_u24 v6, 262144, v2
    v_lshl_add_u32 v6, v1, 4, v6
    v_lshrrev_b32_e64 v4, 1, v21
    v_lshl_add_u32 v6, v4, 14, v6
    v_and_b32_e64 v4, 1, v21
    v_lshl_add_u32 v6, v4, 8, v6
    v_add_u32 v23, 1048576, v6
    v_lshl_add_u32 v7, v9, 2, v7
    s_mul_i32 s42, s40, 512
    s_add_u32 s42, s42, 0x400000
    s_add_u32 s43, s42, 65536
    s_add_u32 s98, s42, 131072
    s_add_u32 s99, s42, 196608
    s_mov_b32 s100, 0x200000
    s_lshl_b32 s101, s53, 11
    s_add_u32 s101, s101, 0x201000
    v_min_u32 v8, 30, v9
    v_lshlrev_b32_e64 v8, 3, v8
    v_add_u32 v8, 0x300000, v8
    s_mov_b32 s36, s20
    s_mov_b32 s37, s21
    s_mov_b32 s38, 0x200000
    s_mov_b32 s39, 0x20000
    v_lshlrev_b32 v11, 12, v2
    v_lshrrev_b32 v4, 1, v21
    v_lshl_add_u32 v11, v4, 8, v11
    v_lshl_add_u32 v11, v1, 4, v11
    v_and_b32_e64 v4, 1, v21
    v_lshl_add_u32 v11, v4, 3, v11
    v_lshl_add_u32 v12, v3, 11, v10
    s_lshl_b32 s62, s53, 11
    v_lshl_add_u32 v4, v1, 2, v2
    v_bfe_u32 v5, v4, 3, 2
    v_xor_b32 v5, v5, v4
    v_lshl_add_u32 v13, v5, 4, s62
    v_bfe_u32 v5, v9, 3, 2
    v_xor_b32_e64 v5, v5, v9
    v_lshl_add_u32 v16, v5, 4, s62
    v_sub_u32_e64 v4, 63, v9
    v_bfe_u32 v5, v4, 3, 2
    v_xor_b32_e64 v5, v5, v4
    v_lshl_add_u32 v14, v5, 4, s62
    v_sub_u32 v4, 64, v9
    v_and_b32 v4, 63, v4
    v_bfe_u32 v5, v4, 3, 2
    v_xor_b32_e64 v5, v5, v4
    v_lshl_add_u32 v15, v5, 4, s62
    v_lshrrev_b32_e64 v4, 5, v9
    v_lshl_add_u32 v18, v3, 1, v4
    v_lshlrev_b32 v19, 2, v18
    v_add_u32 v18, 1, v18
    v_mov_b32 v17, s59
    v_mov_b32 v5, s60
    v_cmp_eq_u32 vcc, 1, v4
    v_lshlrev_b32 v20, 2, v1
    v_mul_u32_u24 v244, 16512, v9
    v_mul_u32_u24 v22, 1152, v9
    v_cndmask_b32 v17, v17, v5, vcc
    s_lshl_b32 s55, s2, 7
    s_add_u32 s55, s55, 0x204800
    s_lshl_b32 s54, s2, 3
    s_add_u32 s54, s54, 0x224c00
    s_lshl_b32 s61, s2, 1
    s_sub_u32 s61, 511, s61
    s_sub_u32 s64, s61, 1
    s_mov_b32 s65, 2000000
    v_and_b32 v4, 1, v9
    v_lshlrev_b32 v236, 10, v4
    v_lshrrev_b32 v4, 1, v9
    v_lshl_add_u32 v236, v4, 4, v236
    v_lshl_add_u32 v236, v3, 11, v236
    v_lshlrev_b32 v237, 2, v3
    s_cmp_eq_u32 s53, 2
    s_cselect_b64 s[46:47], -1, 0
    v_mov_b32 v238, v128
    s_mov_b32 exec_lo, 0x22222222
    s_mov_b32 exec_hi, 0x22222222
    v_mov_b32_e64 v238, v129
    s_mov_b32 exec_lo, 0x44444444
    s_mov_b32 exec_hi, 0x44444444
    v_mov_b32_e64 v238, v130
    s_mov_b32 exec_lo, 0x88888888
    s_mov_b32 exec_hi, 0x88888888
    v_mov_b32 v238, v131
    s_mov_b64 exec, -1
    v_mov_b32 v239, 0xffff
    v_mov_b32_e64 v168, v238
    v_mov_b32 v240, 0x30003
    v_mov_b32 v241, 0x80000000
    v_mov_b32 v242, 0
    v_mov_b32 v243, s64
    v_mov_b32 v21, 0xfffffe00
    s_waitcnt lgkmcnt(0)
    s_barrier
    ds_read_b128 v[32:35], v10 offset:43136
    ds_read_b128 v[36:39], v10 offset:44160
    ds_read_b128 v[40:43], v10 offset:45184
    ds_read_b128 v[44:47], v10 offset:46208
    ds_read_b128 v[24:27], v10 offset:47232
    ds_read_b128 v[28:31], v10 offset:48256
    ds_read_b128 v[56:59], v10 offset:49280
    ds_read_b128 v[64:67], v10 offset:50304
    ds_read_b128 v[60:63], v10 offset:51328
    ds_read_b128 v[68:71], v10 offset:52352
    ds_read_b128 v[72:75], v10 offset:53376
    s_waitcnt vmcnt(5)
    v_lshlrev_b32 v76, 16, v108
    v_and_b32 v77, 0xffff0000, v108
    v_lshlrev_b32_e64 v78, 16, v109
    v_and_b32 v79, 0xffff0000, v109
    v_lshlrev_b32_e64 v80, 16, v110
    v_and_b32 v81, 0xffff0000, v110
    v_lshlrev_b32_e64 v82, 16, v111
    v_and_b32 v83, 0xffff0000, v111
    s_waitcnt vmcnt(4)
    v_lshlrev_b32 v84, 16, v112
    v_and_b32 v85, 0xffff0000, v112
    v_lshlrev_b32_e64 v86, 16, v113
    v_and_b32 v87, 0xffff0000, v113
    v_lshlrev_b32_e64 v88, 16, v114
    v_and_b32 v89, 0xffff0000, v114
    v_lshlrev_b32_e64 v90, 16, v115
    v_and_b32 v91, 0xffff0000, v115
    s_waitcnt vmcnt(3)
    v_lshlrev_b32 v108, 16, v116
    v_and_b32 v109, 0xffff0000, v116
    v_lshlrev_b32_e64 v110, 16, v117
    v_and_b32 v111, 0xffff0000, v117
    s_waitcnt vmcnt(2)
    v_lshlrev_b32 v112, 16, v118
    v_and_b32 v113, 0xffff0000, v118
    v_lshlrev_b32_e64 v114, 16, v119
    v_and_b32 v115, 0xffff0000, v119
    s_waitcnt lgkmcnt(8)
    v_xor_b32 v48, 0x80008000, v40
    v_xor_b32 v49, 0x80008000, v41
    v_xor_b32 v50, 0x80008000, v42
    v_xor_b32 v51, 0x80008000, v43
    s_waitcnt lgkmcnt(7)
    v_xor_b32 v52, 0x80008000, v44
    v_xor_b32 v53, 0x80008000, v45
    v_xor_b32 v54, 0x80008000, v46
    v_xor_b32 v55, 0x80008000, v47
    s_waitcnt vmcnt(2) lgkmcnt(0)
    s_cmp_lg_u32 s2, 0
    s_nop 0
    s_cbranch_scc1 R_NOSA
    buffer_load_dword v168, v7, s[24:27], s100 offen sc1
R_NOSA:
    buffer_load_dwordx4 v[132:135], v6, s[24:27], s42 offen sc1
    buffer_load_dwordx4 v[136:139], v6, s[24:27], s43 offen sc1
    buffer_load_dwordx4 v[140:143], v6, s[24:27], s98 offen sc1
    buffer_load_dwordx4 v[144:147], v6, s[24:27], s99 offen sc1
    buffer_load_dwordx4 v[148:151], v23, s[24:27], s42 offen sc1
    buffer_load_dwordx4 v[152:155], v23, s[24:27], s43 offen sc1
    buffer_load_dwordx4 v[156:159], v23, s[24:27], s98 offen sc1
    buffer_load_dwordx4 v[160:163], v23, s[24:27], s99 offen sc1
    buffer_load_dword v164, v7, s[24:27], s100 offen offset:2048 sc1
    s_mov_b32 s3, s53
    s_cmp_lt_u32 s53, 4
    s_cbranch_scc0 R_NOTL
    buffer_load_dwordx4 v[172:175], v10, s[24:27], s101 offen offset:0 sc1
    buffer_load_dwordx4 v[176:179], v10, s[24:27], s101 offen offset:1024 sc1
R_NOTL:
    s_mov_b64 s[44:45], -1
    s_waitcnt vmcnt(8)
    v_xor_b32 v196, v124, v132
    v_xor_b32 v200, v125, v133
    v_xor_b32 v204, v126, v134
    v_xor_b32_e64 v208, v127, v135
    v_bitop3_b32 v4, v196, v200, v204 bitop3:0xfe
    v_or_b32 v4, v4, v208
    s_waitcnt vmcnt(7)
    v_xor_b32 v197, v124, v136
    v_xor_b32 v201, v125, v137
    v_xor_b32 v205, v126, v138
    v_xor_b32 v209, v127, v139
    v_bitop3_b32 v4, v4, v197, v201 bitop3:0xfe
    v_bitop3_b32 v4, v4, v205, v209 bitop3:0xfe
    s_waitcnt vmcnt(6)
    v_xor_b32 v198, v124, v140
    v_xor_b32 v202, v125, v141
    v_xor_b32 v206, v126, v142
    v_xor_b32_e64 v210, v127, v143
    v_bitop3_b32 v4, v4, v198, v202 bitop3:0xfe
    v_bitop3_b32 v4, v4, v206, v210 bitop3:0xfe
    s_waitcnt vmcnt(5)
    v_xor_b32 v199, v124, v144
    v_xor_b32 v203, v125, v145
    v_xor_b32 v207, v126, v146
    v_xor_b32_e64 v211, v127, v147
    v_bitop3_b32 v4, v4, v199, v203 bitop3:0xfe
    v_bitop3_b32 v4, v4, v207, v211 bitop3:0xfe
    v_mfma_f32_16x16x32_f16 v[180:183], v[24:27], v[196:199], 0
    v_mfma_f32_16x16x32_f16 v[184:187], v[24:27], v[200:203], 0
    v_mfma_f32_16x16x32_f16 v[188:191], v[24:27], v[204:207], 0
    v_mfma_f32_16x16x32_f16 v[192:195], v[24:27], v[208:211], 0
    s_waitcnt vmcnt(4)
    v_xor_b32 v212, v124, v148
    v_xor_b32 v216, v125, v149
    v_xor_b32 v220, v126, v150
    v_xor_b32_e64 v224, v127, v151
    v_bitop3_b32 v4, v4, v212, v216 bitop3:0xfe
    v_bitop3_b32 v4, v4, v220, v224 bitop3:0xfe
    s_waitcnt vmcnt(3)
    v_xor_b32 v213, v124, v152
    v_xor_b32 v217, v125, v153
    v_xor_b32 v221, v126, v154
    v_xor_b32_e64 v225, v127, v155
    v_bitop3_b32 v4, v4, v213, v217 bitop3:0xfe
    v_bitop3_b32 v4, v4, v221, v225 bitop3:0xfe
    s_waitcnt vmcnt(2)
    v_xor_b32 v214, v124, v156
    v_xor_b32 v218, v125, v157
    v_xor_b32 v222, v126, v158
    v_xor_b32_e64 v226, v127, v159
    v_bitop3_b32 v4, v4, v214, v218 bitop3:0xfe
    v_bitop3_b32 v4, v4, v222, v226 bitop3:0xfe
    s_waitcnt vmcnt(1)
    v_xor_b32 v215, v124, v160
    v_xor_b32 v219, v125, v161
    v_xor_b32 v223, v126, v162
    v_xor_b32_e64 v227, v127, v163
    v_mfma_f32_16x16x32_f16 v[180:183], v[28:31], v[212:215], v[180:183]
    v_mfma_f32_16x16x32_f16 v[184:187], v[28:31], v[216:219], v[184:187]
    v_mfma_f32_16x16x32_f16 v[188:191], v[28:31], v[220:223], v[188:191]
    v_mfma_f32_16x16x32_f16 v[192:195], v[28:31], v[224:227], v[192:195]
    s_waitcnt vmcnt(0)
    v_xor_b32 v228, v238, v164
    v_xor_b32 v229, v238, v164
    v_xor_b32 v232, v238, v168
    v_bitop3_b32 v4, v4, v215, v219 bitop3:0xfe
    v_bitop3_b32 v4, v4, v223, v227 bitop3:0xfe
    v_bitop3_b32 v5, v228, v232, v239 bitop3:0xa8
    v_permlane16_swap_b32_e64 v228, v229
    v_bitop3_b32 v4, v4, v240, v5 bitop3:0xea
    v_mov_b32 v230, v228
    v_mov_b32 v231, v229
    v_cmp_ne_u32 vcc, 0, v4
    s_nop 0
    s_cmp_lg_u64 vcc, 0
    s_cbranch_scc1 R_RETRY
R_DATA_OK:
    v_permlane32_swap_b32 v228, v230
    v_permlane32_swap_b32 v229, v231
    v_pk_mul_f32 v[182:183], v[182:183], v[228:229] op_sel:[0,0] op_sel_hi:[1,0]
    v_pk_mul_f32 v[180:181], v[180:181], v[228:229] op_sel:[0,0] op_sel_hi:[1,0]
    v_pk_mul_f32 v[186:187], v[186:187], v[228:229] op_sel:[0,1] op_sel_hi:[1,1]
    v_pk_mul_f32 v[184:185], v[184:185], v[228:229] op_sel:[0,1] op_sel_hi:[1,1]
    v_pk_mul_f32 v[190:191], v[190:191], v[230:231] op_sel:[0,0] op_sel_hi:[1,0]
    v_pk_mul_f32 v[188:189], v[188:189], v[230:231] op_sel:[0,0] op_sel_hi:[1,0]
    v_pk_mul_f32 v[194:195], v[194:195], v[230:231] op_sel:[0,1] op_sel_hi:[1,1]
    v_pk_mul_f32 v[192:193], v[192:193], v[230:231] op_sel:[0,1] op_sel_hi:[1,1]
    s_cmp_lg_u32 s2, 0
    s_cbranch_scc1 R_NOSHIFT
    v_mov_b32 v233, v232
    s_nop 1
    v_permlane16_swap_b32 v232, v233
    v_mov_b32 v234, v232
    v_mov_b32 v235, v233
    s_nop 0
    v_permlane32_swap_b32 v232, v234
    v_permlane32_swap_b32 v233, v235
    s_mov_b64 exec, 0xffff
    v_add_f32 v180, v180, v232
    v_add_f32 v184, v184, v233
    v_add_f32 v188, v188, v234
    v_add_f32 v192, v192, v235
    s_mov_b64 exec, -1
    s_nop 1
R_NOSHIFT:
    v_cvt_pk_bf16_f32 v96, v182, v186
    v_cvt_pk_bf16_f32 v97, v190, v194
    ds_write_b64 v11, v[96:97] offset:20480
    v_cvt_pk_bf16_f32 v98, v183, v187
    v_cvt_pk_bf16_f32 v99, v191, v195
    ds_write_b64 v11, v[98:99] offset:21504
    v_cvt_pk_bf16_f32 v92, v180, v184
    v_cvt_pk_bf16_f32 v93, v188, v192
    ds_write_b64 v11, v[92:93] offset:18432
    v_cvt_pk_bf16_f32 v94, v181, v185
    v_cvt_pk_bf16_f32 v95, v189, v193
    ds_write_b64 v11, v[94:95] offset:19456
    s_cmp_lg_u32 s53, 7
    s_cbranch_scc1 R_NOFL
    buffer_load_dwordx2 v[120:121], v8, s[24:27], 0 offen sc1
R_NOFL:
    s_cmp_ge_u32 s3, 4
    s_cbranch_scc1 R_TAB_DONE
    s_mov_b32 s65, 2000000
R_TAB:
    s_sub_u32 s65, s65, 1
    s_cselect_b64 s[44:45], 0, -1
    s_waitcnt vmcnt(0)
    v_xor_b32 v180, v128, v172
    v_xor_b32 v181, v129, v173
    v_xor_b32 v182, v130, v174
    v_xor_b32 v183, v131, v175
    v_xor_b32 v184, v128, v176
    v_xor_b32 v185, v129, v177
    v_xor_b32 v186, v130, v178
    v_xor_b32_e64 v187, v131, v179
    v_bitop3_b32 v5, v180, v181, v182 bitop3:0xfe
    v_bitop3_b32 v5, v5, v183, v184 bitop3:0xfe
    v_bitop3_b32 v5, v5, v185, v186 bitop3:0xfe
    v_or_b32_e64 v5, v5, v187
    v_and_b32 v5, 0xffff, v5
    v_cmp_ne_u32_e64 vcc, 0, v5
    v_pk_mul_f32 v[188:189], v[180:181], v[108:109]
    v_pk_mul_f32 v[190:191], v[182:183], v[110:111]
    v_pk_mul_f32 v[192:193], v[184:185], v[112:113]
    v_pk_mul_f32 v[194:195], v[186:187], v[114:115]
    s_and_b64 vcc, vcc, s[44:45]
    s_cbranch_scc1 R_TRETRY
    ds_write_b128 v236, v[180:183] offset:54400
    ds_write_b128 v236, v[184:187] offset:54912
    v_pk_add_f32 v[100:101], v[188:189], v[190:191]
    v_pk_add_f32 v[102:103], v[192:193], v[194:195]
    v_pk_add_f32 v[100:101], v[100:101], v[102:103]
    v_add_f32 v5, v100, v101
    s_mov_b64 exec, s[46:47]
    ds_write_b128 v236, v[188:191] offset:58496
    ds_write_b128 v236, v[192:195] offset:59008
    s_mov_b64 exec, -1
    v_add_f32_dpp v5, v5, v5 quad_perm:[1,0,3,2] row_mask:0xf bank_mask:0xf
    s_nop 1
    v_add_f32_dpp v5, v5, v5 quad_perm:[2,3,0,1] row_mask:0xf bank_mask:0xf
    s_nop 1
    v_add_f32_dpp v5, v5, v5 row_half_mirror row_mask:0xf bank_mask:0xf
    s_nop 1
    v_add_f32_dpp v5, v5, v5 row_mirror row_mask:0xf bank_mask:0xf
    s_nop 1
    v_add_f32_dpp v5, v5, v5 row_bcast:15 row_mask:0xa bank_mask:0xf
    s_nop 1
    v_add_f32_dpp v5, v5, v5 row_bcast:31 row_mask:0xc bank_mask:0xf
    s_mov_b32 exec_lo, 0
    s_mov_b32 exec_hi, 0x80000000
    ds_write_b32 v237, v5 offset:34884
    s_mov_b64 exec, -1
R_TAB_DONE:
    s_waitcnt lgkmcnt(0)
    s_barrier
    s_setprio 1
    ds_read_b128 v[132:135], v12 offset:18432
    ds_read_b128 v[136:139], v12 offset:19456
    s_waitcnt lgkmcnt(1)
    v_mfma_f32_16x16x32_bf16 v[140:143], v[132:135], v[32:35], 0
    v_mfma_f32_16x16x32_bf16 v[148:151], v[132:135], v[48:51], 0
    s_waitcnt lgkmcnt(0)
    v_mfma_f32_16x16x32_bf16 v[140:143], v[136:139], v[40:43], v[140:143]
    v_mfma_f32_16x16x32_bf16 v[148:151], v[136:139], v[32:35], v[148:151]
    v_mfma_f32_16x16x32_bf16 v[144:147], v[132:135], v[36:39], 0
    v_mfma_f32_16x16x32_bf16 v[152:155], v[132:135], v[52:55], 0
    v_mfma_f32_16x16x32_bf16 v[144:147], v[136:139], v[44:47], v[144:147]
    v_mfma_f32_16x16x32_bf16 v[152:155], v[136:139], v[36:39], v[152:155]
    ds_read_b128 v[196:199], v10 offset:54400
    ds_read_b128 v[200:203], v10 offset:55424
    ds_read_b128 v[228:231], v10 offset:62592
    ds_read_b128 v[232:235], v10 offset:63616
    ds_read_b64 v[172:173], v242 offset:34888
    v_mul_f32 v92, v140, v56
    v_mul_f32 v93, v141, v57
    v_mul_f32 v94, v142, v58
    v_mul_f32 v95, v143, v59
    v_mul_f32 v96, v148, v56
    v_mul_f32 v97, v149, v57
    v_mul_f32 v98, v150, v58
    v_mul_f32 v99, v151, v59
    v_fmac_f32 v92, v148, v64
    v_fma_f32 v96, -v140, v64, v96
    v_fmac_f32_e64 v93, v149, v65
    v_fma_f32 v97, -v141, v65, v97
    v_fmac_f32_e64 v94, v150, v66
    v_fma_f32 v98, -v142, v66, v98
    v_fmac_f32_e64 v95, v151, v67
    v_fma_f32 v99, -v143, v67, v99
    v_cvt_pk_bf16_f32 v156, v92, v93
    v_cvt_pk_bf16_f32 v157, v94, v95
    v_cvt_pk_bf16_f32 v158, v96, v97
    v_cvt_pk_bf16_f32 v159, v98, v99
    s_nop 1
    v_mfma_f32_16x16x32_bf16 v[180:183], v[156:159], v[72:75], 0
    s_cmp_lg_u32 s53, 7
    s_cbranch_scc1 R_HEAD_DONE
    s_waitcnt vmcnt(0)
    v_cmp_ne_u64 vcc, s[68:69], v[120:121]
    s_nop 0
    s_cmp_lg_u64 vcc, 0
    s_cbranch_scc1 R_FPOLL
R_FILL_OK:
    s_mov_b64 exec, 0xff
    buffer_store_dword v240, v244, s[24:27], s55 offen sc1
    s_mov_b64 exec, -1
R_HEAD_DONE:
    v_mul_f32 v100, v144, v60
    v_mul_f32 v101, v145, v61
    v_mul_f32 v102, v146, v62
    v_mul_f32 v103, v147, v63
    v_mul_f32 v104, v152, v60
    v_mul_f32 v105, v153, v61
    v_mul_f32 v106, v154, v62
    v_mul_f32_e64 v107, v155, v63
    ds_write_b128 v13, v[180:183] offset:0
    ds_read_b128 v[204:207], v16 offset:0
    ds_read_b32 v4, v15 offset:0
    ds_read_b128 v[188:191], v14 offset:0
    v_fmac_f32_e64 v100, v152, v68
    v_fma_f32 v104, -v144, v68, v104
    v_fmac_f32_e64 v101, v153, v69
    v_fma_f32 v105, -v145, v69, v105
    v_fmac_f32_e64 v102, v154, v70
    v_fma_f32 v106, -v146, v70, v106
    v_fmac_f32_e64 v103, v155, v71
    v_fma_f32 v107, -v147, v71, v107
    v_cvt_pk_bf16_f32 v160, v100, v101
    v_cvt_pk_bf16_f32 v161, v102, v103
    v_cvt_pk_bf16_f32 v162, v104, v105
    v_cvt_pk_bf16_f32 v163, v106, v107
    s_nop 1
    v_mfma_f32_16x16x32_bf16 v[184:187], v[160:163], v[72:75], 0
    s_setprio 0
    s_waitcnt lgkmcnt(2)
    v_fmac_f32 v76, v196, v204
    v_fmac_f32 v77, v197, v205
    v_fmac_f32 v78, v198, v206
    v_fmac_f32 v79, v199, v207
    s_waitcnt lgkmcnt(1)
    v_fmac_f32 v84, v196, v4
    s_waitcnt lgkmcnt(0)
    v_fmac_f32 v89, v201, v191
    v_fmac_f32 v90, v202, v190
    v_fmac_f32_e64 v91, v203, v189
    ds_write_b128 v13, v[184:187] offset:1024
    ds_read_b128 v[208:211], v16 offset:1024
    ds_read_b128 v[192:195], v14 offset:1024
    v_mul_f32 v166, v76, v76
    v_mul_f32 v168, v76, v228
    v_add_f32 v164, v76, v77
    v_fmac_f32 v166, v77, v77
    v_fmac_f32 v168, v77, v229
    v_add_f32 v164, v164, v78
    v_fmac_f32 v166, v78, v78
    v_fmac_f32 v168, v78, v230
    v_add_f32 v164, v164, v79
    v_fmac_f32 v166, v79, v79
    v_fmac_f32 v168, v79, v231
    v_mul_f32 v167, v84, v84
    v_mul_f32 v169, v84, v228
    v_add_f32 v165, v84, v89
    v_fmac_f32 v167, v89, v89
    v_fmac_f32 v169, v89, v233
    v_add_f32 v165, v165, v90
    v_fmac_f32 v167, v90, v90
    v_fmac_f32 v169, v90, v234
    v_add_f32 v165, v165, v91
    v_fmac_f32 v167, v91, v91
    v_fmac_f32 v169, v91, v235
    s_waitcnt lgkmcnt(1)
    v_fmac_f32 v80, v200, v208
    v_fmac_f32 v81, v201, v209
    v_fmac_f32 v82, v202, v210
    v_fmac_f32 v83, v203, v211
    s_waitcnt lgkmcnt(0)
    v_fmac_f32 v85, v197, v195
    v_fmac_f32 v86, v198, v194
    v_fmac_f32 v87, v199, v193
    v_fmac_f32 v88, v200, v192
    v_add_f32 v164, v164, v80
    v_fmac_f32 v166, v80, v80
    v_fmac_f32 v168, v80, v232
    v_add_f32 v164, v164, v81
    v_fmac_f32 v166, v81, v81
    v_fmac_f32 v168, v81, v233
    v_add_f32 v164, v164, v82
    v_fmac_f32 v166, v82, v82
    v_fmac_f32 v168, v82, v234
    v_add_f32 v164, v164, v83
    v_fmac_f32 v166, v83, v83
    v_fmac_f32 v168, v83, v235
    v_add_f32 v165, v165, v85
    v_fmac_f32 v167, v85, v85
    v_fmac_f32 v169, v85, v229
    v_add_f32 v165, v165, v86
    v_fmac_f32 v167, v86, v86
    v_fmac_f32 v169, v86, v230
    v_add_f32 v165, v165, v87
    v_fmac_f32 v167, v87, v87
    v_fmac_f32 v169, v87, v231
    v_add_f32 v165, v165, v88
    v_fmac_f32 v167, v88, v88
    v_fmac_f32 v169, v88, v232
    v_permlane32_swap_b32 v164, v165
    v_permlane32_swap_b32 v166, v167
    v_permlane32_swap_b32 v168, v169
    v_add_f32 v164, v164, v165
    v_add_f32 v166, v166, v167
    v_add_f32 v168, v168, v169
    v_add_f32_dpp v164, v164, v164 quad_perm:[1,0,3,2] row_mask:0xf bank_mask:0xf
    v_add_f32_dpp v166, v166, v166 quad_perm:[1,0,3,2] row_mask:0xf bank_mask:0xf
    v_add_f32_dpp v168, v168, v168 quad_perm:[1,0,3,2] row_mask:0xf bank_mask:0xf
    v_add_f32_dpp v164, v164, v164 quad_perm:[2,3,0,1] row_mask:0xf bank_mask:0xf
    v_add_f32_dpp v166, v166, v166 quad_perm:[2,3,0,1] row_mask:0xf bank_mask:0xf
    v_add_f32_dpp v168, v168, v168 quad_perm:[2,3,0,1] row_mask:0xf bank_mask:0xf
    v_add_f32_dpp v164, v164, v164 row_half_mirror row_mask:0xf bank_mask:0xf
    v_add_f32_dpp v166, v166, v166 row_half_mirror row_mask:0xf bank_mask:0xf
    v_add_f32_dpp v168, v168, v168 row_half_mirror row_mask:0xf bank_mask:0xf
    v_add_f32_dpp v164, v164, v164 row_mirror row_mask:0xf bank_mask:0xf
    v_add_f32_dpp v166, v166, v166 row_mirror row_mask:0xf bank_mask:0xf
    v_add_f32_dpp v168, v168, v168 row_mirror row_mask:0xf bank_mask:0xf
    v_add_f32_dpp v164, v164, v164 row_bcast:15 row_mask:0xa bank_mask:0xf
    v_add_f32_dpp v166, v166, v166 row_bcast:15 row_mask:0xa bank_mask:0xf
    v_add_f32_dpp v168, v168, v168 row_bcast:15 row_mask:0xa bank_mask:0xf
    v_mul_f32 v164, 0x3b000000, v164
    v_mul_f32 v166, 0x3b000000, v166
    v_fma_f32 v166, -v164, v164, v166
    v_max_f32_e64 v166, 0, v166
    v_add_f32 v166, 0x3727c5ac, v166
    v_rsq_f32_e64 v166, v166
    v_fma_f32 v168, -v164, v173, v168
    v_fma_f32 v168, v168, v166, v172
    v_ashrrev_i32_e64 v92, 31, v168
    s_mov_b32 exec_lo, 0x80000000
    s_mov_b32 exec_hi, 0x80000000
    v_bitop3_b32 v92, v92, v241, v168 bitop3:0x56
    v_bitop3_b32 v92, v92, v17, v18 bitop3:0xea
    ds_write_b32 v19, v92 offset:34816
    s_mov_b64 exec, -1
    v_readlane_b32 s46, v92, 31
    v_readlane_b32 s47, v92, 63
    s_nop 0
    s_max_u32 s48, s46, s47
    s_and_b32 s65, s48, 0xfffffe00
    s_or_b32 s65, s65, s61
    v_mov_b32 v92, s65
    v_mov_b32_e64 v5, s48
    s_waitcnt lgkmcnt(0)
    s_barrier
    s_setprio 2
    ds_read_b32 v4, v20 offset:34816
    s_waitcnt lgkmcnt(0)
    v_cmp_lt_u32 vcc, v5, v4
    v_sub_u32_e64 v93, v4, v5
    s_cmp_lg_u64 vcc, 0
    s_cbranch_scc1 R_NOPUB
    v_max_u32_dpp v93, v93, v93 quad_perm:[1,0,3,2] row_mask:0xf bank_mask:0xf
    s_nop 1
    v_max_u32_dpp v93, v93, v93 quad_perm:[2,3,0,1] row_mask:0xf bank_mask:0xf
    s_nop 1
    v_max_u32_dpp v93, v93, v93 row_half_mirror row_mask:0xf bank_mask:0xf
    s_nop 1
    v_max_u32_dpp v93, v93, v93 row_mirror row_mask:0xf bank_mask:0xf
    s_mov_b64 exec, 255
    v_add_u32 v93, v93, v5
    v_bitop3_b32 v93, v93, v21, v243 bitop3:0xea
    buffer_store_dwordx2 v[92:93], v22, s[24:27], s54 offen sc1
    s_mov_b64 exec, -1
    s_nop 0
R_NOPUB:
    s_setprio 0
    ds_read_b128 v[212:215], v10 offset:58496
    ds_read_b128 v[216:219], v10 offset:59520
    ds_read_b128 v[204:207], v10 offset:56448
    ds_read_b128 v[208:211], v10 offset:57472
    ds_read_b128 v[220:223], v10 offset:60544
    ds_read_b128 v[224:227], v10 offset:61568
    v_mul_f32 v164, v164, v166
    v_cmp_lt_u32_e64 s[40:41], s46, v4
    v_cmp_lt_u32_e64 s[42:43], s47, v4
    v_readlane_b32 s66, v166, 31
    v_readlane_b32 s44, v164, 31
    v_readlane_b32 s67, v166, 63
    v_readlane_b32 s45, v164, 63
    v_mov_b32 v164, s44
    v_mov_b32 v166, s66
    v_mov_b32 v165, s45
    v_mov_b32 v167, s67
    s_and_b32 s40, s40, 0xffff
    s_bcnt1_i32_b32 s40, s40
    s_sub_u32 s41, s61, s40
    s_lshl_b32 s50, s41, 10
    s_add_u32 s50, s50, 0x1f0800
    s_lshl_b32 s62, s41, 2
    s_add_u32 s62, s62, 0x203c08
    s_cmp_lt_u32 s40, 2
    s_cselect_b32 s50, s50, 0x7fff0000
    s_cselect_b32 s62, s62, 0x7fff0000
    s_and_b32 s42, s42, 0xffff
    s_bcnt1_i32_b32 s42, s42
    s_sub_u32 s43, s61, s42
    s_lshl_b32 s51, s43, 10
    s_add_u32 s51, s51, 0x1f0800
    s_lshl_b32 s63, s43, 2
    s_add_u32 s63, s63, 0x203c08
    s_cmp_lt_u32 s42, 2
    s_cselect_b32 s51, s51, 0x7fff0000
    s_cselect_b32 s63, s63, 0x7fff0000
    v_fma_f32 v180, v76, v166, -v164
    v_fma_f32 v181, v77, v166, -v164
    v_fma_f32 v182, v78, v166, -v164
    v_fma_f32 v183, v79, v166, -v164
    v_fma_f32 v184, v80, v166, -v164
    v_fma_f32 v185, v81, v166, -v164
    v_fma_f32 v186, v82, v166, -v164
    v_fma_f32 v187, v83, v166, -v164
    s_waitcnt lgkmcnt(3)
    v_fma_f32 v180, v180, v212, v204
    v_fma_f32 v181, v181, v213, v205
    v_fma_f32 v182, v182, v214, v206
    v_fma_f32 v183, v183, v215, v207
    s_waitcnt lgkmcnt(2)
    v_fma_f32 v184, v184, v216, v208
    v_fma_f32 v185, v185, v217, v209
    v_fma_f32 v186, v186, v218, v210
    v_fma_f32 v187, v187, v219, v211
    v_cvt_pk_bf16_f32 v140, v180, v181
    v_cvt_pk_bf16_f32 v141, v182, v183
    v_cvt_pk_bf16_f32 v142, v184, v185
    v_cvt_pk_bf16_f32 v143, v186, v187
    buffer_store_dwordx4 v[140:143], v10, s[24:27], s50 offen sc1
    v_fma_f32 v188, v84, v167, -v165
    v_fma_f32 v189, v85, v167, -v165
    v_fma_f32 v190, v86, v167, -v165
    v_fma_f32 v191, v87, v167, -v165
    v_fma_f32 v192, v88, v167, -v165
    v_fma_f32 v193, v89, v167, -v165
    v_fma_f32 v194, v90, v167, -v165
    v_fma_f32 v195, v91, v167, -v165
    v_fma_f32 v188, v188, v212, v204
    v_fma_f32 v189, v189, v213, v205
    v_fma_f32 v190, v190, v214, v206
    v_fma_f32 v191, v191, v215, v207
    v_fma_f32 v192, v192, v216, v208
    v_fma_f32 v193, v193, v217, v209
    v_fma_f32 v194, v194, v218, v210
    v_fma_f32 v195, v195, v219, v211
    v_cvt_pk_bf16_f32 v144, v188, v189
    v_cvt_pk_bf16_f32 v145, v190, v191
    v_cvt_pk_bf16_f32 v146, v192, v193
    v_cvt_pk_bf16_f32 v147, v194, v195
    buffer_store_dwordx4 v[144:147], v10, s[24:27], s51 offen sc1
    s_waitcnt lgkmcnt(1)
    v_fmac_f32 v76, v220, v180
    v_fmac_f32 v77, v221, v181
    v_fmac_f32 v78, v222, v182
    v_fmac_f32 v79, v223, v183
    s_waitcnt lgkmcnt(0)
    v_fmac_f32 v80, v224, v184
    v_fmac_f32 v81, v225, v185
    v_fmac_f32 v82, v226, v186
    v_fmac_f32 v83, v227, v187
    v_cvt_pk_bf16_f32 v148, v76, v77
    v_cvt_pk_bf16_f32 v149, v78, v79
    v_cvt_pk_bf16_f32 v150, v80, v81
    v_cvt_pk_bf16_f32 v151, v82, v83
    buffer_store_dwordx4 v[148:151], v10, s[36:39], s57 offen sc1
    v_fmac_f32 v84, v220, v188
    v_fmac_f32 v85, v221, v189
    v_fmac_f32 v86, v222, v190
    v_fmac_f32 v87, v223, v191
    v_fmac_f32 v88, v224, v192
    v_fmac_f32 v89, v225, v193
    v_fmac_f32 v90, v226, v194
    v_fmac_f32 v91, v227, v195
    v_cvt_pk_bf16_f32 v152, v84, v85
    v_cvt_pk_bf16_f32 v153, v86, v87
    v_cvt_pk_bf16_f32 v154, v88, v89
    v_cvt_pk_bf16_f32 v155, v90, v91
    buffer_store_dwordx4 v[152:155], v10, s[36:39], s58 offen sc1
    s_add_u32 s52, s52, 1
    s_add_u32 s56, s56, 1
    v_mov_b32 v92, s52
    v_mov_b32 v93, s56
    s_mov_b64 exec, 1
    s_waitcnt vmcnt(0)
    buffer_store_dword v92, off, s[24:27], s62 sc1
    buffer_store_dword v93, off, s[24:27], s63 sc1
    s_endpgm
R_RETRY:
    v_cmp_ne_u32_e64 s[48:49], 0, v5
    v_bitop3_b32 v92, v196, v200, v204 bitop3:0xfe
    v_bitop3_b32 v92, v92, v208, v240 bitop3:0xa8
    v_cmp_ne_u32_e64 s[8:9], 0, v92
    v_bitop3_b32 v93, v197, v201, v205 bitop3:0xfe
    v_bitop3_b32 v93, v93, v209, v240 bitop3:0xa8
    v_cmp_ne_u32_e64 s[10:11], 0, v93
    v_bitop3_b32 v94, v198, v202, v206 bitop3:0xfe
    v_bitop3_b32 v94, v94, v210, v240 bitop3:0xa8
    v_cmp_ne_u32_e64 s[12:13], 0, v94
    v_bitop3_b32 v95, v199, v203, v207 bitop3:0xfe
    v_bitop3_b32 v95, v95, v211, v240 bitop3:0xa8
    v_cmp_ne_u32_e64 s[14:15], 0, v95
    v_bitop3_b32 v96, v212, v216, v220 bitop3:0xfe
    v_bitop3_b32 v96, v96, v224, v240 bitop3:0xa8
    v_cmp_ne_u32_e64 s[16:17], 0, v96
    v_bitop3_b32 v97, v213, v217, v221 bitop3:0xfe
    v_bitop3_b32 v97, v97, v225, v240 bitop3:0xa8
    v_cmp_ne_u32_e64 s[18:19], 0, v97
    v_bitop3_b32 v98, v214, v218, v222 bitop3:0xfe
    v_bitop3_b32 v98, v98, v226, v240 bitop3:0xa8
    v_cmp_ne_u32_e64 s[20:21], 0, v98
    v_bitop3_b32 v99, v215, v219, v223 bitop3:0xfe
    v_bitop3_b32 v99, v99, v227, v240 bitop3:0xa8
    v_cmp_ne_u32_e64 s[22:23], 0, v99
    s_nop 4
R_RLOOP:
    s_cmp_eq_u64 s[8:9], 0
    s_cbranch_scc1 R_SK0
    buffer_load_dwordx4 v[132:135], v6, s[24:27], s42 offen sc1
R_SK0:
    s_cmp_eq_u64 s[10:11], 0
    s_cbranch_scc1 R_SK1
    buffer_load_dwordx4 v[136:139], v6, s[24:27], s43 offen sc1
R_SK1:
    s_cmp_eq_u64 s[12:13], 0
    s_cbranch_scc1 R_SK2
    buffer_load_dwordx4 v[140:143], v6, s[24:27], s98 offen sc1
R_SK2:
    s_cmp_eq_u64 s[14:15], 0
    s_cbranch_scc1 R_SK3
    buffer_load_dwordx4 v[144:147], v6, s[24:27], s99 offen sc1
R_SK3:
    s_cmp_eq_u64 s[16:17], 0
    s_cbranch_scc1 R_SK4
    buffer_load_dwordx4 v[148:151], v23, s[24:27], s42 offen sc1
R_SK4:
    s_cmp_eq_u64 s[18:19], 0
    s_cbranch_scc1 R_SK5
    buffer_load_dwordx4 v[152:155], v23, s[24:27], s43 offen sc1
R_SK5:
    s_cmp_eq_u64 s[20:21], 0
    s_cbranch_scc1 R_SK6
    buffer_load_dwordx4 v[156:159], v23, s[24:27], s98 offen sc1
R_SK6:
    s_cmp_eq_u64 s[22:23], 0
    s_cbranch_scc1 R_SK7
    buffer_load_dwordx4 v[160:163], v23, s[24:27], s99 offen sc1
R_SK7:
    s_cmp_eq_u64 s[48:49], 0
    s_cbranch_scc1 R_SK8
    buffer_load_dword v164, v7, s[24:27], s100 offen offset:2048 sc1
    s_cmp_lg_u32 s2, 0
    s_cbranch_scc1 R_SK8
    buffer_load_dword v168, v7, s[24:27], s100 offen sc1
R_SK8:
    s_cmp_ge_u32 s3, 4
    s_cbranch_scc1 R_RWAIT
    v_xor_b32 v180, v128, v172
    v_xor_b32 v181, v129, v173
    v_xor_b32 v182, v130, v174
    v_xor_b32 v183, v131, v175
    v_xor_b32 v184, v128, v176
    v_xor_b32 v185, v129, v177
    v_xor_b32 v186, v130, v178
    v_xor_b32 v187, v131, v179
    v_bitop3_b32 v5, v180, v181, v182 bitop3:0xfe
    v_bitop3_b32 v5, v5, v183, v184 bitop3:0xfe
    v_bitop3_b32 v5, v5, v185, v186 bitop3:0xfe
    v_or_b32_e64 v5, v5, v187
    v_and_b32 v5, 0xffff, v5
    v_cmp_ne_u32_e64 vcc, 0, v5
    v_pk_mul_f32 v[188:189], v[180:181], v[108:109]
    v_pk_mul_f32 v[190:191], v[182:183], v[110:111]
    v_pk_mul_f32 v[192:193], v[184:185], v[112:113]
    v_pk_mul_f32 v[194:195], v[186:187], v[114:115]
    s_and_b64 vcc, vcc, s[44:45]
    s_cbranch_scc1 R_RTAB
    ds_write_b128 v236, v[180:183] offset:54400
    ds_write_b128 v236, v[184:187] offset:54912
    v_pk_add_f32 v[100:101], v[188:189], v[190:191]
    v_pk_add_f32 v[102:103], v[192:193], v[194:195]
    v_pk_add_f32 v[100:101], v[100:101], v[102:103]
    v_add_f32 v5, v100, v101
    s_mov_b64 exec, s[46:47]
    ds_write_b128 v236, v[188:191] offset:58496
    ds_write_b128 v236, v[192:195] offset:59008
    s_mov_b64 exec, -1
    v_add_f32_dpp v5, v5, v5 quad_perm:[1,0,3,2] row_mask:0xf bank_mask:0xf
    s_nop 1
    v_add_f32_dpp v5, v5, v5 quad_perm:[2,3,0,1] row_mask:0xf bank_mask:0xf
    s_nop 1
    v_add_f32_dpp v5, v5, v5 row_half_mirror row_mask:0xf bank_mask:0xf
    s_nop 1
    v_add_f32_dpp v5, v5, v5 row_mirror row_mask:0xf bank_mask:0xf
    s_nop 1
    v_add_f32_dpp v5, v5, v5 row_bcast:15 row_mask:0xa bank_mask:0xf
    s_nop 1
    v_add_f32_dpp v5, v5, v5 row_bcast:31 row_mask:0xc bank_mask:0xf
    s_mov_b32 exec_lo, 0
    s_mov_b32 exec_hi, 0x80000000
    ds_write_b32 v237, v5 offset:34884
    s_mov_b64 exec, -1
    s_mov_b32 s3, 4
    s_waitcnt lgkmcnt(0)
    s_branch R_RWAIT
R_RTAB:
    buffer_load_dwordx4 v[172:175], v10, s[24:27], s101 offen offset:0 sc1
    buffer_load_dwordx4 v[176:179], v10, s[24:27], s101 offen offset:1024 sc1
R_RWAIT:
    s_waitcnt vmcnt(0)
    v_xor_b32 v228, v238, v164
    v_xor_b32 v229, v238, v164
    v_xor_b32_e64 v232, v238, v168
    v_bitop3_b32 v5, v228, v232, v239 bitop3:0xa8
    v_cmp_ne_u32_e64 s[48:49], 0, v5
    s_cmp_eq_u64 s[8:9], 0
    s_cbranch_scc1 R_SX0
    v_xor_b32 v196, v124, v132
    v_xor_b32 v200, v125, v133
    v_xor_b32 v204, v126, v134
    v_xor_b32 v208, v127, v135
    v_bitop3_b32 v92, v196, v200, v204 bitop3:0xfe
    v_bitop3_b32 v92, v92, v208, v240 bitop3:0xa8
    v_cmp_ne_u32_e64 s[8:9], 0, v92
R_SX0:
    s_cmp_eq_u64 s[10:11], 0
    s_cbranch_scc1 R_SX1
    v_xor_b32 v197, v124, v136
    v_xor_b32 v201, v125, v137
    v_xor_b32 v205, v126, v138
    v_xor_b32 v209, v127, v139
    v_bitop3_b32 v93, v197, v201, v205 bitop3:0xfe
    v_bitop3_b32 v93, v93, v209, v240 bitop3:0xa8
    v_cmp_ne_u32_e64 s[10:11], 0, v93
R_SX1:
    s_cmp_eq_u64 s[12:13], 0
    s_cbranch_scc1 R_SX2
    v_xor_b32 v198, v124, v140
    v_xor_b32 v202, v125, v141
    v_xor_b32 v206, v126, v142
    v_xor_b32 v210, v127, v143
    v_bitop3_b32 v94, v198, v202, v206 bitop3:0xfe
    v_bitop3_b32 v94, v94, v210, v240 bitop3:0xa8
    v_cmp_ne_u32_e64 s[12:13], 0, v94
R_SX2:
    s_cmp_eq_u64 s[14:15], 0
    s_cbranch_scc1 R_SX3
    v_xor_b32 v199, v124, v144
    v_xor_b32 v203, v125, v145
    v_xor_b32 v207, v126, v146
    v_xor_b32 v211, v127, v147
    v_bitop3_b32 v95, v199, v203, v207 bitop3:0xfe
    v_bitop3_b32 v95, v95, v211, v240 bitop3:0xa8
    v_cmp_ne_u32_e64 s[14:15], 0, v95
R_SX3:
    s_cmp_eq_u64 s[16:17], 0
    s_cbranch_scc1 R_SX4
    v_xor_b32 v212, v124, v148
    v_xor_b32 v216, v125, v149
    v_xor_b32 v220, v126, v150
    v_xor_b32 v224, v127, v151
    v_bitop3_b32 v96, v212, v216, v220 bitop3:0xfe
    v_bitop3_b32 v96, v96, v224, v240 bitop3:0xa8
    v_cmp_ne_u32_e64 s[16:17], 0, v96
R_SX4:
    s_cmp_eq_u64 s[18:19], 0
    s_cbranch_scc1 R_SX5
    v_xor_b32 v213, v124, v152
    v_xor_b32 v217, v125, v153
    v_xor_b32 v221, v126, v154
    v_xor_b32 v225, v127, v155
    v_bitop3_b32 v97, v213, v217, v221 bitop3:0xfe
    v_bitop3_b32 v97, v97, v225, v240 bitop3:0xa8
    v_cmp_ne_u32_e64 s[18:19], 0, v97
R_SX5:
    s_cmp_eq_u64 s[20:21], 0
    s_cbranch_scc1 R_SX6
    v_xor_b32 v214, v124, v156
    v_xor_b32 v218, v125, v157
    v_xor_b32 v222, v126, v158
    v_xor_b32 v226, v127, v159
    v_bitop3_b32 v98, v214, v218, v222 bitop3:0xfe
    v_bitop3_b32 v98, v98, v226, v240 bitop3:0xa8
    v_cmp_ne_u32_e64 s[20:21], 0, v98
R_SX6:
    s_cmp_eq_u64 s[22:23], 0
    s_cbranch_scc1 R_SX7
    v_xor_b32 v215, v124, v160
    v_xor_b32 v219, v125, v161
    v_xor_b32 v223, v126, v162
    v_xor_b32 v227, v127, v163
    v_bitop3_b32 v99, v215, v219, v223 bitop3:0xfe
    v_bitop3_b32 v99, v99, v227, v240 bitop3:0xa8
    v_cmp_ne_u32_e64 s[22:23], 0, v99
R_SX7:
    v_permlane16_swap_b32_e64 v228, v229
    v_mfma_f32_16x16x32_f16 v[180:183], v[24:27], v[196:199], 0
    s_or_b64 s[50:51], s[48:49], s[8:9]
    v_mfma_f32_16x16x32_f16 v[184:187], v[24:27], v[200:203], 0
    s_or_b64 s[50:51], s[50:51], s[10:11]
    v_mfma_f32_16x16x32_f16 v[188:191], v[24:27], v[204:207], 0
    s_or_b64 s[50:51], s[50:51], s[12:13]
    v_mfma_f32_16x16x32_f16 v[192:195], v[24:27], v[208:211], 0
    s_or_b64 s[50:51], s[50:51], s[14:15]
    v_mfma_f32_16x16x32_f16 v[180:183], v[28:31], v[212:215], v[180:183]
    s_or_b64 s[50:51], s[50:51], s[16:17]
    v_mfma_f32_16x16x32_f16 v[184:187], v[28:31], v[216:219], v[184:187]
    s_or_b64 s[50:51], s[50:51], s[18:19]
    v_mfma_f32_16x16x32_f16 v[188:191], v[28:31], v[220:223], v[188:191]
    s_or_b64 s[50:51], s[50:51], s[20:21]
    v_mfma_f32_16x16x32_f16 v[192:195], v[28:31], v[224:227], v[192:195]
    s_or_b64 s[50:51], s[50:51], s[22:23]
    v_mov_b32 v230, v228
    v_mov_b32 v231, v229
    s_sub_u32 s65, s65, 1
    s_cselect_b64 s[50:51], 0, s[50:51]
    s_cmp_lg_u64 s[50:51], 0
    s_nop 1
    s_cbranch_scc1 R_RLOOP
    s_branch R_DATA_OK
R_TRETRY:
    buffer_load_dwordx4 v[172:175], v10, s[24:27], s101 offen offset:0 sc1
    buffer_load_dwordx4 v[176:179], v10, s[24:27], s101 offen offset:1024 sc1
    s_branch R_TAB
R_FPOLL:
    s_mov_b32 s3, 2000000
R_POLL:
    buffer_load_dwordx2 v[120:121], v8, s[24:27], 0 offen sc1
    s_sub_u32 s3, s3, 1
    s_waitcnt vmcnt(0)
    v_cmp_ne_u64_e64 vcc, s[68:69], v[120:121]
    s_nop 0
    s_cselect_b64 vcc, 0, vcc
    s_and_b64 exec, exec, vcc
    s_nop 1
    s_cbranch_scc0 R_POLL_OK
    s_sleep 2
    s_branch R_POLL
R_POLL_OK:
    s_mov_b64 exec, -1
    s_branch R_FILL_OK
L_FILL:
    s_sub_u32 s40, s2, 225
    s_mul_i32 s41, s40, 24576
    v_lshlrev_b32 v1, 4, v0
    v_mov_b32 v4, -1
    v_mov_b32 v8, 0
    v_mov_b32 v5, -1
    v_mov_b32 v9, 0
    v_mov_b32 v6, -1
    v_mov_b32 v10, 0
    v_mov_b32 v7, -1
    v_mov_b32_e64 v11, 0
    s_mov_b32 s3, 0x301000
    s_waitcnt lgkmcnt(0)
    s_load_dwordx8 s[72:79], s[6:7], s3
    s_load_dwordx2 s[68:69], s[6:7], s3 offset:32
    s_add_u32 s28, s6, 0x230000
    s_addc_u32 s29, s7, 0
    s_mov_b32 s30, 0xb0800
    s_mov_b32 s31, 0x20000
    s_add_u32 s32, s6, 0x204000
    s_addc_u32 s33, s7, 0
    s_mov_b32 s34, 0x23000
    s_mov_b32 s35, 0x20000
    s_lshl_b32 s43, s40, 13
    buffer_store_dwordx4 v[8:11], v1, s[32:35], s43 offen sc1
    buffer_store_dwordx4 v[4:7], v1, s[28:31], s41 offen sc1
    s_add_u32 s42, s41, 8192
    buffer_store_dwordx4 v[4:7], v1, s[28:31], s42 offen sc1
    s_add_u32 s42, s41, 16384
    buffer_store_dwordx4 v[4:7], v1, s[28:31], s42 offen sc1
    s_waitcnt lgkmcnt(0)
    s_add_u32 s68, s68, 0x9e3779b9
    s_addc_u32 s69, s69, 0x7f4a7c15
    s_mov_b32 s24, s6
    s_mov_b32 s25, s7
    s_mov_b32 s26, 0x600000
    s_mov_b32 s27, 0x20000
    v_readfirstlane_b32 s44, v0
    s_lshl_b32 s45, s40, 3
    s_add_u32 s45, s45, 0x300000
    s_cmp_eq_u32 s44, 0
    s_cselect_b32 s45, s45, 0x7fff0000
    s_waitcnt vmcnt(0)
    s_barrier
    v_mov_b32 v8, s68
    v_mov_b32_e64 v9, s69
    s_mov_b64 exec, 1
    buffer_store_dwordx2 v[8:9], off, s[24:27], s45 sc1
    s_mov_b64 exec, -1
    s_waitcnt lgkmcnt(0)
    s_cmp_ge_u32 s2, 241
    s_cbranch_scc1 L_END
    s_branch L_FFN
M_REST:
    s_mov_b32 s3, 0x301000
    s_load_dwordx8 s[72:79], s[6:7], s3
    s_load_dwordx2 s[68:69], s[6:7], s3 offset:32
    s_add_u32 s32, s6, 0x200000
    s_addc_u32 s33, s7, 0
    s_mov_b32 s34, 0x3000
    s_mov_b32 s35, 0x20000
    s_lshl_b32 s43, s41, 5
    v_add_u32 v5, s43, v0
    v_readfirstlane_b32 s54, v0
    s_waitcnt vmcnt(7)
    v_lshlrev_b32 v28, 16, v28
    s_waitcnt vmcnt(6)
    v_lshlrev_b32 v29, 16, v29
    s_waitcnt vmcnt(5)
    v_lshlrev_b32 v30, 16, v30
    s_waitcnt vmcnt(4)
    v_lshlrev_b32 v31, 16, v31
    v_mul_f32 v32, 0xbfb8aa3b, v28
    v_mul_f32 v33, 0xbfb8aa3b, v29
    v_mul_f32 v34, 0xbfb8aa3b, v30
    v_mul_f32 v35, 0xbfb8aa3b, v31
    v_exp_f32 v32, v32
    v_exp_f32 v33, v33
    v_exp_f32 v34, v34
    v_exp_f32 v35, v35
    v_add_f32 v32, 1.0, v32
    v_add_f32 v33, 1.0, v33
    v_add_f32 v34, 1.0, v34
    v_add_f32 v35, 1.0, v35
    v_rcp_f32 v32, v32
    v_rcp_f32 v33, v33
    v_rcp_f32 v34, v34
    v_rcp_f32 v35, v35
    v_mul_f32 v28, v28, v32
    v_mul_f32 v29, v29, v33
    v_mul_f32 v30, v30, v34
    v_mul_f32 v31, v31, v35
    v_cvt_pk_bf16_f32 v32, v28, v29
    v_lshlrev_b32_e64 v28, 16, v32
    v_and_b32 v29, 0xffff0000, v32
    v_cvt_pk_bf16_f32 v33, v30, v31
    v_lshlrev_b32_e64 v30, 16, v33
    v_and_b32 v31, 0xffff0000, v33
    s_waitcnt lgkmcnt(0)
    s_add_u32 s68, s68, 0x9e3779b9
    s_addc_u32 s69, s69, 0x7f4a7c15
    s_or_b32 s72, s72, 0xfffcfffc
    s_or_b32 s73, s73, 0xfffcfffc
    s_or_b32 s74, s74, 0xfffcfffc
    s_or_b32 s75, s75, 0xfffcfffc
    s_add_u32 s72, s72, 1
    s_addc_u32 s73, s73, 0
    s_addc_u32 s74, s74, 0
    s_addc_u32 s75, s75, 0
    s_and_b32 s72, s72, 0x30003
    s_and_b32 s73, s73, 0x30003
    s_and_b32 s74, s74, 0x30003
    s_and_b32 s75, s75, 0x30003
    s_add_u32 s76, s76, 1
    s_and_b32 s76, s76, 0xffff
    s_add_u32 s77, s77, 1
    s_and_b32 s77, s77, 0xffff
    s_add_u32 s78, s78, 1
    s_and_b32 s78, s78, 0xffff
    s_add_u32 s79, s79, 1
    s_and_b32 s79, s79, 0xffff
    v_and_b32 v6, 3, v5
    v_mov_b32 v9, s76
    v_mov_b32 v7, s77
    v_cmp_eq_u32 vcc, 1, v6
    s_nop 1
    v_cndmask_b32 v9, v9, v7, vcc
    v_mov_b32 v7, s78
    v_cmp_eq_u32 vcc, 2, v6
    s_nop 1
    v_cndmask_b32 v9, v9, v7, vcc
    v_mov_b32 v7, s79
    v_cmp_eq_u32 vcc, 3, v6
    s_nop 1
    v_cndmask_b32 v9, v9, v7, vcc
    v_lshlrev_b32 v5, 2, v5
    v_lshrrev_b32 v8, 4, v0
    v_lshlrev_b32 v8, 7, v8
    v_lshl_add_u32 v8, v2, 5, v8
    v_and_b32 v6, 31, v0
    v_lshrrev_b32 v7, 5, v0
    v_lshlrev_b32_e64 v36, 11, v7
    v_lshl_add_u32 v36, v6, 2, v36
    v_add_u32 v37, 1024, v36
    s_lshr_b32 s42, s41, 4
    s_cmp_eq_u32 s42, 1
    s_cselect_b32 s56, 1.0, 0
    s_cmp_eq_u32 s42, 4
    s_cselect_b32 s56, 1.0, s56
    s_cmp_eq_u32 s42, 0
    s_cselect_b32 s57, 0x45000000, 1.0
    s_waitcnt vmcnt(3)
    v_lshlrev_b32 v48, 16, v12
    v_and_b32 v49, 0xffff0000, v12
    v_lshlrev_b32_e64 v50, 16, v13
    v_and_b32 v51, 0xffff0000, v13
    v_lshlrev_b32_e64 v52, 16, v14
    v_and_b32 v53, 0xffff0000, v14
    v_lshlrev_b32_e64 v54, 16, v15
    v_and_b32 v55, 0xffff0000, v15
    v_mul_f32 v40, v48, v28
    v_mul_f32 v41, v49, v28
    v_mul_f32 v42, v50, v28
    v_mul_f32 v43, v51, v28
    v_mul_f32 v44, v52, v28
    v_mul_f32 v45, v53, v28
    v_mul_f32 v46, v54, v28
    v_mul_f32 v47, v55, v28
    s_waitcnt vmcnt(2)
    v_lshlrev_b32 v48, 16, v16
    v_and_b32 v49, 0xffff0000, v16
    v_lshlrev_b32_e64 v50, 16, v17
    v_and_b32 v51, 0xffff0000, v17
    v_lshlrev_b32_e64 v52, 16, v18
    v_and_b32 v53, 0xffff0000, v18
    v_lshlrev_b32_e64 v54, 16, v19
    v_and_b32 v55, 0xffff0000, v19
    v_fmac_f32 v40, v48, v29
    v_fmac_f32 v41, v49, v29
    v_fmac_f32 v42, v50, v29
    v_fmac_f32 v43, v51, v29
    v_fmac_f32 v44, v52, v29
    v_fmac_f32 v45, v53, v29
    v_fmac_f32 v46, v54, v29
    v_fmac_f32 v47, v55, v29
    s_waitcnt vmcnt(1)
    v_lshlrev_b32 v48, 16, v20
    v_and_b32 v49, 0xffff0000, v20
    v_lshlrev_b32_e64 v50, 16, v21
    v_and_b32 v51, 0xffff0000, v21
    v_lshlrev_b32_e64 v52, 16, v22
    v_and_b32 v53, 0xffff0000, v22
    v_lshlrev_b32_e64 v54, 16, v23
    v_and_b32 v55, 0xffff0000, v23
    v_fmac_f32 v40, v48, v30
    v_fmac_f32 v41, v49, v30
    v_fmac_f32 v42, v50, v30
    v_fmac_f32 v43, v51, v30
    v_fmac_f32 v44, v52, v30
    v_fmac_f32 v45, v53, v30
    v_fmac_f32 v46, v54, v30
    v_fmac_f32 v47, v55, v30
    s_waitcnt vmcnt(0)
    v_lshlrev_b32 v48, 16, v24
    v_and_b32 v49, 0xffff0000, v24
    v_lshlrev_b32_e64 v50, 16, v25
    v_and_b32 v51, 0xffff0000, v25
    v_lshlrev_b32_e64 v52, 16, v26
    v_and_b32 v53, 0xffff0000, v26
    v_lshlrev_b32_e64 v54, 16, v27
    v_and_b32 v55, 0xffff0000, v27
    v_fmac_f32 v40, v48, v31
    v_fmac_f32 v41, v49, v31
    v_fmac_f32 v42, v50, v31
    v_fmac_f32 v43, v51, v31
    v_fmac_f32 v44, v52, v31
    v_fmac_f32 v45, v53, v31
    v_fmac_f32 v46, v54, v31
    v_fmac_f32 v47, v55, v31
    v_add_f32_dpp v40, v40, v40 row_ror:4 row_mask:0xf bank_mask:0xf
    v_add_f32_dpp v41, v41, v41 row_ror:4 row_mask:0xf bank_mask:0xf
    v_add_f32_dpp v42, v42, v42 row_ror:4 row_mask:0xf bank_mask:0xf
    v_add_f32_dpp v43, v43, v43 row_ror:4 row_mask:0xf bank_mask:0xf
    v_add_f32_dpp v44, v44, v44 row_ror:4 row_mask:0xf bank_mask:0xf
    v_add_f32_dpp v45, v45, v45 row_ror:4 row_mask:0xf bank_mask:0xf
    v_add_f32_dpp v46, v46, v46 row_ror:4 row_mask:0xf bank_mask:0xf
    v_add_f32_dpp v47, v47, v47 row_ror:4 row_mask:0xf bank_mask:0xf
    v_add_f32_dpp v40, v40, v40 row_ror:8 row_mask:0xf bank_mask:0xf
    v_add_f32_dpp v41, v41, v41 row_ror:8 row_mask:0xf bank_mask:0xf
    v_add_f32_dpp v42, v42, v42 row_ror:8 row_mask:0xf bank_mask:0xf
    v_add_f32_dpp v43, v43, v43 row_ror:8 row_mask:0xf bank_mask:0xf
    v_add_f32_dpp v44, v44, v44 row_ror:8 row_mask:0xf bank_mask:0xf
    v_add_f32_dpp v45, v45, v45 row_ror:8 row_mask:0xf bank_mask:0xf
    v_add_f32_dpp v46, v46, v46 row_ror:8 row_mask:0xf bank_mask:0xf
    v_add_f32_dpp v47, v47, v47 row_ror:8 row_mask:0xf bank_mask:0xf
    s_mov_b32 exec_lo, 0x000f000f
    s_mov_b32 exec_hi, 0x000f000f
    ds_write_b128 v8, v[40:43]
    ds_write_b128 v8, v[44:47] offset:16
    s_mov_b64 exec, -1
    s_waitcnt lgkmcnt(0)
    s_barrier
    s_cmp_ge_u32 s54, 64
    s_cbranch_scc1 L_MOD3
    ds_read2_b32 v[56:57], v36 offset0:0 offset1:32
    ds_read2_b32 v[58:59], v36 offset0:64 offset1:96
    ds_read2_b32 v[60:61], v36 offset0:128 offset1:160
    ds_read2_b32 v[62:63], v36 offset0:192 offset1:224
    ds_read2_b32 v[64:65], v37 offset0:0 offset1:32
    ds_read2_b32 v[66:67], v37 offset0:64 offset1:96
    ds_read2_b32 v[68:69], v37 offset0:128 offset1:160
    ds_read2_b32 v[70:71], v37 offset0:192 offset1:224
    s_waitcnt lgkmcnt(3)
    v_add_f32 v56, v56, v64
    v_add_f32 v57, v57, v65
    s_waitcnt lgkmcnt(2)
    v_add_f32 v58, v58, v66
    v_add_f32 v59, v59, v67
    s_waitcnt lgkmcnt(1)
    v_add_f32 v60, v60, v68
    v_add_f32 v61, v61, v69
    s_waitcnt lgkmcnt(0)
    v_add_f32 v62, v62, v70
    v_add_f32 v63, v63, v71
    v_add_f32 v56, v56, v60
    v_add_f32 v57, v57, v61
    v_add_f32 v58, v58, v62
    v_add_f32 v59, v59, v63
    v_add_f32 v56, v56, v58
    v_add_f32 v57, v57, v59
    v_add_f32 v56, v56, v57
    v_mov_b32 v57, v56
    s_nop 1
    v_permlane32_swap_b32 v56, v57
    v_add_f32 v56, v56, v57
    v_cvt_pk_bf16_f32 v56, v56, v56
    v_lshlrev_b32 v56, 16, v56
    v_add_f32 v56, s56, v56
    v_mul_f32_e64 v56, s57, v56
    v_cvt_pk_bf16_f32 v56, v56, v56
    v_lshl_or_b32 v56, v56, 16, v9
    s_mov_b32 exec_hi, 0
    buffer_store_dword v56, v5, s[32:35], 0 offen sc1
    s_mov_b64 exec, -1
    s_waitcnt lgkmcnt(0)
L_MOD3:
    s_barrier
L_FFN:
    v_and_b32_e64 v1, 15, v0
    v_bfe_u32 v2, v0, 4, 2
    v_lshrrev_b32_e64 v3, 6, v0
    s_sub_u32 s40, s2, 129
    s_and_b32 s64, s40, 7
    s_mul_i32 s41, s64, 14
    s_lshr_b32 s42, s40, 3
    s_add_u32 s41, s41, s42
    v_readfirstlane_b32 s43, v3
    s_mov_b32 s24, s6
    s_mov_b32 s25, s7
    s_mov_b32 s26, 0x600000
    s_mov_b32 s27, 0x20000
    s_cmp_ge_u32 s43, 4
    s_cbranch_scc1 FFN_DOWN
    s_mov_b32 s28, s10
    s_mov_b32 s29, s11
    s_mov_b32 s30, 0x1c0000
    s_mov_b32 s31, 0x20000
    s_mov_b32 s32, s12
    s_mov_b32 s33, s13
    s_mov_b32 s34, 0x1c0000
    s_mov_b32 s35, 0x20000
    v_bfe_u32 v5, v0, 1, 5
    v_mul_u32_u24 v4, 3584, v5
    v_and_b32 v5, 1, v0
    v_lshl_add_u32 v4, v5, 4, v4
    s_mul_i32 s44, s43, 458752
    s_lshl_b32 s45, s41, 5
    s_add_u32 s44, s44, s45
    s_lshl_b32 s45, s43, 13
    s_add_u32 s46, s41, 0
    s_and_b32 s46, s46, 3
    s_mul_i32 s47, s46, 114688
    s_add_u32 s47, s47, s44
    s_lshl_b32 s46, s46, 10
    s_add_u32 s46, s46, s45
    s_add_u32 m0, s46, 18432
    s_nop 0
    buffer_load_dwordx4 v4, s[28:31], s47 offen lds
    s_add_u32 m0, s46, 22528
    s_nop 0
    buffer_load_dwordx4 v4, s[32:35], s47 offen lds
    s_add_u32 s46, s41, 1
    s_and_b32 s46, s46, 3
    s_mul_i32 s47, s46, 114688
    s_add_u32 s47, s47, s44
    s_lshl_b32 s46, s46, 10
    s_add_u32 s46, s46, s45
    s_add_u32 m0, s46, 18432
    s_nop 0
    buffer_load_dwordx4 v4, s[28:31], s47 offen lds
    s_add_u32 m0, s46, 22528
    s_nop 0
    buffer_load_dwordx4 v4, s[32:35], s47 offen lds
    s_add_u32 s46, s41, 2
    s_and_b32 s46, s46, 3
    s_mul_i32 s47, s46, 114688
    s_add_u32 s47, s47, s44
    s_lshl_b32 s46, s46, 10
    s_add_u32 s46, s46, s45
    s_add_u32 m0, s46, 18432
    s_nop 0
    buffer_load_dwordx4 v4, s[28:31], s47 offen lds
    s_add_u32 m0, s46, 22528
    s_nop 0
    buffer_load_dwordx4 v4, s[32:35], s47 offen lds
    s_add_u32 s46, s41, 3
    s_and_b32 s46, s46, 3
    s_mul_i32 s47, s46, 114688
    s_add_u32 s47, s47, s44
    s_lshl_b32 s46, s46, 10
    s_add_u32 s46, s46, s45
    s_add_u32 m0, s46, 18432
    s_nop 0
    buffer_load_dwordx4 v4, s[28:31], s47 offen lds
    s_add_u32 m0, s46, 22528
    s_nop 0
    buffer_load_dwordx4 v4, s[32:35], s47 offen lds
    v_lshlrev_b32 v7, 13, v3
    v_lshl_add_u32 v7, v2, 8, v7
    v_lshl_add_u32 v7, v1, 3, v7
    v_and_b32 v8, 63, v0
    v_min_u32 v5, 30, v8
    v_lshlrev_b32_e64 v5, 3, v5
    v_add_u32 v5, 0x300000, v5
    buffer_load_dwordx2 v[12:13], v5, s[24:27], 0 offen sc1
    v_lshlrev_b32 v8, 7, v8
    v_lshlrev_b32 v9, 8, v3
    v_lshl_add_u32 v9, v2, 4, v9
    v_lshl_add_u32 v10, v1, 6, v9
    s_and_b32 s46, s64, 7
    s_mul_i32 s46, s46, 16512
    s_add_u32 s46, s46, 0x204800
    s_add_u32 s52, s46, 8192
    s_add_u32 s53, s46, 16384
    s_mov_b32 s47, 0x170800
    s_mov_b32 s48, 2000000
    v_lshrrev_b32 v19, 3, v8
    s_mul_i32 s54, s64, 1152
    s_add_u32 s54, s54, 0x224c00
    v_and_b32 v18, 1, v0
    v_lshlrev_b32 v18, 10, v18
    v_add_u32 v9, 524288, v9
    v_mov_b32 v20, 0
    v_mov_b32 v21, 0
    v_mov_b32 v22, 0
    v_mov_b32 v23, 0
    v_mov_b32 v24, 0
    v_mov_b32 v25, 0
    v_mov_b32 v26, 0
    v_mov_b32 v27, 0
    v_mov_b32 v28, 0
    v_mov_b32 v29, 0
    v_mov_b32 v30, 0
    v_mov_b32 v31, 0
    v_mov_b32 v32, 0
    v_mov_b32 v33, 0
    v_mov_b32 v34, 0
    v_mov_b32_e64 v35, 0
    s_waitcnt vmcnt(0)
    ds_read_b64_tr_b16 v[36:37], v7 offset:18432
    ds_read_b64_tr_b16 v[38:39], v7 offset:18560
    ds_read_b64_tr_b16 v[52:53], v7 offset:22528
    ds_read_b64_tr_b16 v[54:55], v7 offset:22656
    ds_read_b64_tr_b16 v[40:41], v7 offset:19456
    ds_read_b64_tr_b16 v[42:43], v7 offset:19584
    ds_read_b64_tr_b16 v[56:57], v7 offset:23552
    ds_read_b64_tr_b16 v[58:59], v7 offset:23680
    ds_read_b64_tr_b16 v[44:45], v7 offset:20480
    ds_read_b64_tr_b16 v[46:47], v7 offset:20608
    ds_read_b64_tr_b16 v[60:61], v7 offset:24576
    ds_read_b64_tr_b16 v[62:63], v7 offset:24704
    ds_read_b64_tr_b16 v[48:49], v7 offset:21504
    ds_read_b64_tr_b16 v[50:51], v7 offset:21632
    ds_read_b64_tr_b16 v[64:65], v7 offset:25600
    ds_read_b64_tr_b16 v[66:67], v7 offset:25728
    s_barrier
    v_cmp_ne_u64 vcc, s[68:69], v[12:13]
    s_nop 0
    s_cmp_eq_u64 vcc, 0
    s_nop 2
    s_cbranch_scc1 FFN_HEAD0
    s_mov_b32 s49, 2000000
FFN_POLL_FILL:
    buffer_load_dwordx2 v[12:13], v5, s[24:27], 0 offen sc1
    s_sub_u32 s49, s49, 1
    s_waitcnt vmcnt(0)
    v_cmp_ne_u64_e64 vcc, s[68:69], v[12:13]
    s_nop 0
    s_cselect_b64 vcc, 0, vcc
    s_and_b64 exec, exec, vcc
    s_nop 1
    s_cbranch_scc0 FFN_POLL_FILL_OK
    s_sleep 2
    s_branch FFN_POLL_FILL
FFN_POLL_FILL_OK:
    s_mov_b64 exec, -1
FFN_HEAD0:
    s_lshl_b32 s52, s43, 12
    s_add_u32 s46, s46, s52
    s_cmp_eq_u32 s43, 3
    s_cselect_b32 exec_hi, 1, 0
FFN_POLL_HEAD:
    buffer_load_dword v5, v8, s[24:27], s46 offen sc1
    s_sub_u32 s48, s48, 1
    s_waitcnt vmcnt(0)
    v_cmp_eq_u32_e64 vcc, 0, v5
    s_nop 0
    s_cselect_b64 vcc, 0, vcc
    s_and_b64 exec, exec, vcc
    s_nop 1
    s_cbranch_scc0 FFN_HEAD_OK
    s_sleep 2
    s_branch FFN_POLL_HEAD
FFN_HEAD_OK:
    s_mov_b64 exec, -1
    s_mov_b32 s48, 2000000
    s_barrier
FFN_POLL_KEYS:
    buffer_load_dwordx4 v[12:15], v19, s[24:27], s54 offen sc1
    buffer_load_dword v16, off, s[24:27], s54 offset:1024 sc1
    s_sub_u32 s48, s48, 1
    s_waitcnt vmcnt(1)
    v_min3_u32 v5, v12, v13, v14
    s_waitcnt vmcnt(0)
    v_min3_u32 v5, v5, v15, v16
    v_cmp_eq_u32 vcc, 0, v5
    s_nop 0
    s_cselect_b64 vcc, 0, vcc
    s_and_b64 exec, exec, vcc
    s_nop 1
    s_cbranch_scc0 FFN_KEYS_OK
    s_sleep 2
    s_branch FFN_POLL_KEYS
FFN_KEYS_OK:
    s_mov_b64 exec, -1
    s_waitcnt lgkmcnt(0)
    s_mov_b32 s48, 2000000
    v_min_u32 v6, v12, v14
    v_max_u32 v12, v12, v14
    v_max3_u32 v13, v13, v15, v6
    v_readfirstlane_b32 s60, v16
    v_min_u32_dpp v6, v12, v12 quad_perm:[1,0,3,2] row_mask:0xf bank_mask:0xf
    v_max_u32_dpp v12, v12, v12 quad_perm:[1,0,3,2] row_mask:0xf bank_mask:0xf
    v_max_u32_dpp v13, v13, v13 quad_perm:[1,0,3,2] row_mask:0xf bank_mask:0xf
    v_max_u32 v13, v13, v6
    v_min_u32_dpp v6, v12, v12 quad_perm:[2,3,0,1] row_mask:0xf bank_mask:0xf
    v_max_u32_dpp v12, v12, v12 quad_perm:[2,3,0,1] row_mask:0xf bank_mask:0xf
    v_max_u32_dpp v13, v13, v13 quad_perm:[2,3,0,1] row_mask:0xf bank_mask:0xf
    v_max_u32_e64 v13, v13, v6
    v_min_u32_dpp v6, v12, v12 row_half_mirror row_mask:0xf bank_mask:0xf
    v_max_u32_dpp v12, v12, v12 row_half_mirror row_mask:0xf bank_mask:0xf
    v_max_u32_dpp v13, v13, v13 row_half_mirror row_mask:0xf bank_mask:0xf
    v_max_u32_e64 v13, v13, v6
    v_min_u32_dpp v6, v12, v12 row_mirror row_mask:0xf bank_mask:0xf
    v_max_u32_dpp v12, v12, v12 row_mirror row_mask:0xf bank_mask:0xf
    v_max_u32_dpp v13, v13, v13 row_mirror row_mask:0xf bank_mask:0xf
    v_max_u32_e64 v13, v13, v6
    v_min_u32_dpp v6, v12, v12 row_bcast:15 row_mask:0xa bank_mask:0xf
    v_max_u32_dpp v12, v12, v12 row_bcast:15 row_mask:0xa bank_mask:0xf
    v_max_u32_dpp v13, v13, v13 row_bcast:15 row_mask:0xa bank_mask:0xf
    v_max_u32_e64 v13, v13, v6
    v_min_u32_dpp v6, v12, v12 row_bcast:31 row_mask:0xc bank_mask:0xf
    v_max_u32_dpp v12, v12, v12 row_bcast:31 row_mask:0xc bank_mask:0xf
    v_max_u32_dpp v13, v13, v13 row_bcast:31 row_mask:0xc bank_mask:0xf
    v_max_u32_e64 v13, v13, v6
    v_readlane_b32 s58, v12, 63
    v_readlane_b32 s59, v13, 63
    s_min_u32 s61, s58, s60
    s_max_u32 s58, s58, s60
    s_max_u32 s59, s59, s61
    s_and_b32 s60, s58, 0x1ff
    s_and_b32 s61, s59, 0x1ff
    s_sub_u32 s61, s61, s60
    s_lshl_b32 s60, s60, 10
    s_add_u32 s47, s47, s60
    v_mad_i32_i24 v9, v18, s61, v9
    s_nop 2
FFN_POLL_X:
    s_mov_b32 exec_lo, 0x00030003
    s_mov_b32 exec_hi, 0x00030003
    buffer_load_dwordx4 v[20:23], v9, s[24:27], s47 offen offset:0 sc1
    buffer_load_dwordx4 v[24:27], v9, s[24:27], s47 offen offset:64 sc1
    buffer_load_dwordx4 v[28:31], v9, s[24:27], s47 offen offset:128 sc1
    buffer_load_dwordx4 v[32:35], v9, s[24:27], s47 offen offset:192 sc1
    s_mov_b64 exec, -1
    s_sub_u32 s48, s48, 1
    s_cselect_b32 s49, 0, 1
    s_waitcnt vmcnt(3)
    v_mfma_f32_16x16x32_bf16 v[68:71], v[36:39], v[20:23], 0
    v_mfma_f32_16x16x32_bf16 v[72:75], v[52:55], v[20:23], 0
    v_max3_u32 v5, v20, v21, v22
    v_max_u32_e64 v5, v5, v23
    s_waitcnt vmcnt(2)
    v_mfma_f32_16x16x32_bf16 v[68:71], v[40:43], v[24:27], v[68:71]
    v_mfma_f32_16x16x32_bf16 v[72:75], v[56:59], v[24:27], v[72:75]
    v_max3_u32 v5, v5, v24, v25
    v_max3_u32 v5, v5, v26, v27
    s_waitcnt vmcnt(1)
    v_mfma_f32_16x16x32_bf16 v[68:71], v[44:47], v[28:31], v[68:71]
    v_mfma_f32_16x16x32_bf16 v[72:75], v[60:63], v[28:31], v[72:75]
    v_max3_u32 v5, v5, v28, v29
    v_max3_u32 v5, v5, v30, v31
    s_waitcnt vmcnt(0)
    v_mfma_f32_16x16x32_bf16 v[68:71], v[48:51], v[32:35], v[68:71]
    v_mfma_f32_16x16x32_bf16 v[72:75], v[64:67], v[32:35], v[72:75]
    v_max3_u32 v5, v5, v32, v33
    v_max3_u32 v5, v5, v34, v35
    v_cmp_eq_u32 vcc, -1, v5
    s_cmp_eq_u32 s49, 0
    s_cselect_b64 vcc, 0, vcc
    s_cmp_lg_u64 vcc, 0
    s_nop 1
    s_cbranch_scc1 FFN_POLL_X
    s_mov_b32 s48, 2000000
    s_mov_b32 exec_lo, 0x00030003
    s_mov_b32 exec_hi, 0x00030003
    ds_write_b128 v10, v[68:71] offset:51200
    ds_write_b128 v10, v[72:75] offset:51328
    s_mov_b64 exec, -1
    s_waitcnt lgkmcnt(0)
    s_barrier
    s_cmp_lt_u32 s43, 1
    s_cbranch_scc1 FFN_FIN
    s_lshl_b32 s52, s40, 2
    s_add_u32 s52, s52, s43
    s_cmp_lg_u32 s52, 2
    s_cbranch_scc1 L_END
    v_mov_b32 v20, s72
    v_mov_b32 v21, s73
    v_mov_b32 v22, s74
    v_mov_b32 v23, s75
    v_mov_b32 v24, s76
    v_mov_b32 v25, s77
    v_mov_b32 v26, s78
    v_mov_b32 v27, s79
    v_mov_b32 v28, s68
    v_mov_b32_e64 v29, s69
    s_mov_b32 s59, 0x301000
    s_mov_b64 exec, 1
    buffer_store_dwordx4 v[20:23], off, s[24:27], s59 sc1
    buffer_store_dwordx4 v[24:27], off, s[24:27], s59 offset:16 sc1
    buffer_store_dwordx2 v[28:29], off, s[24:27], s59 offset:32 sc1
    s_endpgm
FFN_FIN:
    s_cmp_ge_u32 s40, 64
    s_cbranch_scc1 L_END
    s_lshr_b32 s43, s40, 5
    s_and_b32 s40, s40, 31
    s_mov_b32 s36, s20
    s_mov_b32 s37, s21
    s_mov_b32 s38, 0x200000
    s_mov_b32 s39, 0x20000
    s_cmp_ge_u32 s40, 16
    s_cselect_b32 s52, s59, s58
    v_mov_b32_e64 v76, s52
    v_and_b32 v77, 0x1ff, v76
    v_lshlrev_b32_e64 v77, 2, v77
    s_mov_b32 s54, 0x203c08
    s_and_b32 s55, s40, 15
    s_lshl_b32 s55, s55, 6
    s_lshl_b32 s57, s43, 3
    s_add_u32 s55, s55, s57
    s_lshl_b32 s56, s55, 1
    s_add_u32 s56, s56, 0x202800
    v_and_b32 v79, 3, v0
    v_lshlrev_b32_e64 v79, 4, v79
    v_lshl_add_u32 v80, v2, 1, v79
    v_lshlrev_b32 v5, 1, v80
    v_mov_b32_e64 v82, 0
    s_nop 2
FFN_POLL_DONE:
    buffer_load_dword v78, v77, s[24:27], s54 offen sc1
    buffer_load_dword v81, v5, s[24:27], s56 offen sc1
    s_sub_u32 s48, s48, 1
    s_waitcnt vmcnt(0)
    v_cmp_eq_u32 vcc, 0, v78
    s_nop 0
    s_cselect_b64 vcc, 0, vcc
    s_cmp_lg_u64 vcc, 0
    s_nop 1
    s_cbranch_scc1 FFN_POLL_DONE
    s_mov_b32 s48, 2000000
    v_subrev_u32_e64 v83, 1, v78
    v_lshl_add_u32 v83, v83, 10, v80
    buffer_load_short_d16_hi v82, v83, s[36:39], s55 offen sc1
    v_ashrrev_i32 v84, 31, v76
    v_not_b32 v84, v84
    v_or_b32 v84, 0x80000000, v84
    v_xor_b32_e64 v84, v84, v76
    v_mul_f32 v84, 0xbfb8aa3b, v84
    v_exp_f32 v84, v84
    s_nop 0
    v_add_f32 v84, 1.0, v84
    v_rcp_f32 v84, v84
    v_and_b32 v81, 0xffff0000, v81
    v_mul_f32_e64 v81, v81, v84
    s_mul_i32 s57, s40, 14336
    s_lshl_b32 s58, s43, 6
    s_add_u32 s57, s57, s58
    s_add_u32 s60, s57, 0x270800
    s_add_u32 s61, s60, 4096
    s_add_u32 s62, s60, 8192
    s_add_u32 s63, s60, 12288
    v_bfe_u32 v85, v0, 2, 4
    v_lshlrev_b32 v85, 7, v85
    v_add_u32 v85, v79, v85
    s_barrier
    s_nop 1
FFN_POLL_PART:
    buffer_load_dwordx4 v[88:91], v85, s[24:27], s60 offen offset:0 sc1
    buffer_load_dwordx4 v[92:95], v85, s[24:27], s60 offen offset:2048 sc1
    buffer_load_dwordx4 v[96:99], v85, s[24:27], s61 offen offset:0 sc1
    buffer_load_dwordx4 v[100:103], v85, s[24:27], s61 offen offset:2048 sc1
    buffer_load_dwordx4 v[104:107], v85, s[24:27], s62 offen offset:0 sc1
    buffer_load_dwordx4 v[108:111], v85, s[24:27], s62 offen offset:2048 sc1
    buffer_load_dwordx4 v[112:115], v85, s[24:27], s63 offen offset:0 sc1
    s_sub_u32 s48, s48, 1
    s_cselect_b64 s[50:51], 0, -1
    s_waitcnt vmcnt(6)
    v_max3_u32 v5, v88, v89, v90
    v_max_u32_e64 v5, v5, v91
    s_waitcnt vmcnt(5)
    v_max3_u32 v5, v5, v92, v93
    v_max3_u32 v5, v5, v94, v95
    v_pk_add_f32 v[88:89], v[88:89], v[92:93]
    v_pk_add_f32 v[90:91], v[90:91], v[94:95]
    s_waitcnt vmcnt(4)
    v_max3_u32 v5, v5, v96, v97
    v_max3_u32 v5, v5, v98, v99
    v_pk_add_f32 v[88:89], v[88:89], v[96:97]
    v_pk_add_f32 v[90:91], v[90:91], v[98:99]
    s_waitcnt vmcnt(3)
    v_max3_u32 v5, v5, v100, v101
    v_max3_u32 v5, v5, v102, v103
    v_pk_add_f32 v[88:89], v[88:89], v[100:101]
    v_pk_add_f32 v[90:91], v[90:91], v[102:103]
    s_waitcnt vmcnt(2)
    v_max3_u32 v5, v5, v104, v105
    v_max3_u32 v5, v5, v106, v107
    v_pk_add_f32 v[88:89], v[88:89], v[104:105]
    v_pk_add_f32 v[90:91], v[90:91], v[106:107]
    s_waitcnt vmcnt(1)
    v_max3_u32 v5, v5, v108, v109
    v_max3_u32 v5, v5, v110, v111
    v_pk_add_f32 v[88:89], v[88:89], v[108:109]
    v_pk_add_f32 v[90:91], v[90:91], v[110:111]
    s_waitcnt vmcnt(0)
    v_max3_u32 v5, v5, v112, v113
    v_max3_u32 v5, v5, v114, v115
    v_pk_add_f32 v[88:89], v[88:89], v[112:113]
    v_pk_add_f32 v[90:91], v[90:91], v[114:115]
    v_cmp_eq_u32 vcc, -1, v5
    v_permlane16_swap_b32 v88, v89
    v_permlane16_swap_b32 v90, v91
    s_and_b64 vcc, vcc, s[50:51]
    s_nop 1
    s_cbranch_scc1 FFN_POLL_PART
    v_add_f32 v88, v88, v89
    v_add_f32 v90, v90, v91
    s_nop 1
    v_permlane32_swap_b32 v88, v90
    v_add_f32_e64 v88, v88, v90
    s_nop 1
    v_add_f32_dpp v88, v88, v88 row_ror:4 row_mask:0xf bank_mask:0xf
    s_nop 1
    v_add_f32_dpp v88, v88, v88 row_ror:8 row_mask:0xf bank_mask:0xf
    s_mov_b32 exec_lo, 0x000f000f
    s_mov_b32 exec_hi, 0x000f000f
    v_fmac_f32 v82, v88, v81
    v_cvt_pk_bf16_f32 v82, v82, v82
    buffer_store_short v82, v83, s[36:39], s55 offen sc1
    s_endpgm
FFN_DOWN:
    s_mov_b32 s28, s14
    s_mov_b32 s29, s15
    s_mov_b32 s30, 0x1c0000
    s_mov_b32 s31, 0x20000
    v_and_b32 v5, 3, v3
    v_lshlrev_b32_e64 v4, 12, v2
    v_lshl_add_u32 v4, v5, 8, v4
    v_lshl_add_u32 v4, v1, 4, v4
    s_lshl_b32 s44, s41, 14
    buffer_load_dwordx4 v[8:11], v4, s[28:31], s44 offen offset:0
    buffer_load_dwordx4 v[12:15], v4, s[28:31], s44 offen offset:1024
    buffer_load_dwordx4 v[16:19], v4, s[28:31], s44 offen offset:2048
    buffer_load_dwordx4 v[20:23], v4, s[28:31], s44 offen offset:3072
    s_mov_b32 s52, 0x05040100
    s_mov_b32 s53, 0x07060302
    v_bfe_u32 v6, v1, 2, 1
    v_lshlrev_b32 v24, 6, v6
    v_lshl_add_u32 v24, v2, 4, v24
    v_and_b32 v6, 1, v2
    v_lshlrev_b32 v25, 4, v6
    v_lshl_add_u32 v25, v5, 2, v25
    v_lshrrev_b32 v5, 2, v1
    v_add_u32 v25, v25, v5
    v_mul_u32_u24 v25, 14336, v25
    v_and_b32_e64 v6, 3, v1
    v_lshl_add_u32 v25, v6, 4, v25
    v_lshrrev_b32_e64 v6, 1, v2
    v_lshl_add_u32 v25, v6, 6, v25
    s_lshl_b32 s45, s40, 7
    s_add_u32 s45, s45, 0x270800
    v_sub_u32 v26, 0, v6
    s_waitcnt vmcnt(0)
    s_barrier
    v_perm_b32 v28, v12, v8, s52
    v_perm_b32 v29, v20, v16, s52
    v_perm_b32 v30, v12, v8, s53
    v_perm_b32 v31, v20, v16, s53
    v_perm_b32 v32, v13, v9, s52
    v_perm_b32 v33, v21, v17, s52
    v_perm_b32 v34, v13, v9, s53
    v_perm_b32 v35, v21, v17, s53
    v_perm_b32 v36, v14, v10, s52
    v_perm_b32 v37, v22, v18, s52
    v_perm_b32 v38, v14, v10, s53
    v_perm_b32 v39, v22, v18, s53
    v_perm_b32 v40, v15, v11, s52
    v_perm_b32 v41, v23, v19, s52
    v_perm_b32 v42, v15, v11, s53
    v_perm_b32 v43, v23, v19, s53
    s_barrier
    s_barrier
    ds_read_b128 v[44:47], v24 offset:51200
    ds_read_b128 v[48:51], v24 offset:51328
    ds_read_b128 v[52:55], v24 offset:51456
    ds_read_b128 v[56:59], v24 offset:51584
    ds_read_b128 v[60:63], v24 offset:51712
    ds_read_b128 v[64:67], v24 offset:51840
    ds_read_b128 v[68:71], v24 offset:51968
    ds_read_b128 v[72:75], v24 offset:52096
    s_waitcnt lgkmcnt(5)
    v_pk_add_f32 v[44:45], v[44:45], v[52:53]
    v_pk_add_f32 v[46:47], v[46:47], v[54:55]
    s_waitcnt lgkmcnt(4)
    v_pk_add_f32 v[48:49], v[48:49], v[56:57]
    v_pk_add_f32 v[50:51], v[50:51], v[58:59]
    s_waitcnt lgkmcnt(3)
    v_pk_add_f32 v[44:45], v[44:45], v[60:61]
    v_pk_add_f32 v[46:47], v[46:47], v[62:63]
    s_waitcnt lgkmcnt(2)
    v_pk_add_f32 v[48:49], v[48:49], v[64:65]
    v_pk_add_f32 v[50:51], v[50:51], v[66:67]
    s_waitcnt lgkmcnt(1)
    v_pk_add_f32 v[44:45], v[44:45], v[68:69]
    v_pk_add_f32 v[46:47], v[46:47], v[70:71]
    s_waitcnt lgkmcnt(0)
    v_pk_add_f32 v[48:49], v[48:49], v[72:73]
    v_pk_add_f32 v[50:51], v[50:51], v[74:75]
    v_mul_f32 v52, 0xbfb8aa3b, v44
    v_mul_f32 v53, 0xbfb8aa3b, v45
    v_mul_f32 v54, 0xbfb8aa3b, v46
    v_mul_f32 v55, 0xbfb8aa3b, v47
    v_exp_f32 v52, v52
    v_exp_f32 v53, v53
    v_exp_f32 v54, v54
    v_exp_f32 v55, v55
    v_pk_mul_f32 v[44:45], v[44:45], v[48:49]
    v_pk_mul_f32 v[46:47], v[46:47], v[50:51]
    v_pk_add_f32 v[52:53], v[52:53], 1.0 op_sel_hi:[1,0]
    v_pk_add_f32 v[54:55], v[54:55], 1.0 op_sel_hi:[1,0]
    v_rcp_f32 v52, v52
    v_rcp_f32 v53, v53
    v_rcp_f32 v54, v54
    v_rcp_f32 v55, v55
    v_pk_mul_f32 v[44:45], v[44:45], v[52:53]
    v_pk_mul_f32 v[46:47], v[46:47], v[54:55]
    v_cvt_pk_bf16_f32 v76, v44, v45
    v_cvt_pk_bf16_f32 v77, v46, v47
    s_nop 1
    v_mfma_f32_16x16x16_bf16 v[80:83], v[76:77], v[28:29], 0
    v_mfma_f32_16x16x16_bf16 v[96:99], v[76:77], v[36:37], 0
    v_mfma_f32_16x16x16_bf16 v[84:87], v[76:77], v[30:31], 0
    v_mfma_f32_16x16x16_bf16 v[100:103], v[76:77], v[38:39], 0
    v_mfma_f32_16x16x16_bf16 v[88:91], v[76:77], v[32:33], 0
    v_mfma_f32_16x16x16_bf16 v[104:107], v[76:77], v[40:41], 0
    v_mfma_f32_16x16x16_bf16 v[92:95], v[76:77], v[34:35], 0
    v_mfma_f32_16x16x16_bf16 v[108:111], v[76:77], v[42:43], 0
    s_nop 1
    v_bitop3_b32 v60, v26, v96, v80 bitop3:0xca
    s_nop 0
    v_bitop3_b32 v61, v26, v100, v84 bitop3:0xca
    s_nop 0
    v_bitop3_b32 v62, v26, v104, v88 bitop3:0xca
    s_nop 0
    v_bitop3_b32 v63, v26, v108, v92 bitop3:0xca
    buffer_store_dwordx4 v[60:63], v25, s[24:27], s45 offen sc1
    s_waitcnt vmcnt(0)
    s_barrier
L_END:
    s_endpgm
L_CODE_END:
.section .rodata,"a"
.p2align 6
.amdhsa_kernel adaLN_cond__spectral_fnet__moe_arch_mod__prompt_kernel
  .amdhsa_next_free_vgpr 245
  .amdhsa_next_free_sgpr 102
  .amdhsa_accum_offset 248
  .amdhsa_group_segment_fixed_size 0
  .amdhsa_kernarg_size 120
  .amdhsa_user_sgpr_count 2
  .amdhsa_user_sgpr_kernarg_segment_ptr 1
  .amdhsa_system_sgpr_workgroup_id_x 1
.end_amdhsa_kernel
```
